```python
import torch

def _softmax(x, axis=-1):
    return torch.softmax(x, dim=axis)

def _gelu(x):
    return torch.nn.functional.gelu(x, approximate='tanh')

def _silu(x):
    return torch.nn.functional.silu(x)

def _sigmoid(x):
    return torch.sigmoid(x)

def _layernorm(x, axis=-1, eps=1e-05):
    m = x.mean(dim=axis, keepdim=True)
    v = x.var(dim=axis, keepdim=True, unbiased=False)
    return (x - m) / torch.sqrt(v + eps)

def _scatter_add(tgt, idx, src, axis=0):
    return tgt.clone().index_add_(axis, idx, src)

def _segment_sum(src, seg, n):
    out = torch.zeros((n,) + src.shape[1:], dtype=src.dtype)
    return out.index_add_(0, seg, src)

def _pad(x, pw):
    flat = tuple((v for pair in reversed(pw) for v in pair))
    return torch.nn.functional.pad(x, flat)
kernel_name = 'gather_scatter__tensor_product_equiv_equiformer__graph'

def setup_inputs():

    _w = lambda a: (lambda t: t.to(torch.bfloat16) if t.is_floating_point() else t)(torch.as_tensor(a))
    N, deg, C, De = (12500, 64, 64, max(16, 1))
    E = N * deg
    src = (lambda lo, hi, *s: torch.randint(lo, hi, s))(0, N, E).to(torch.int64)
    dst = (lambda lo, hi, *s: torch.randint(lo, hi, s))(0, N, E).to(torch.int64)
    rvec = (lambda *s: torch.randn(*s, dtype=torch.bfloat16) * 0.05)(E, 3).to(float)
    rn = (torch.linalg.norm(rvec, dim=-1, keepdim=True) + 1e-06).to(float)
    rhat = (rvec / rn).to(float)
    eps = torch.zeros((3, 3, 3), dtype=float)
    eps[0, 1, 2] = eps[1, 2, 0] = eps[2, 0, 1] = 1.0
    eps[0, 2, 1] = eps[2, 1, 0] = eps[1, 0, 2] = -1.0
    return {'x': _w((lambda *s: torch.randn(*s, dtype=torch.bfloat16) * 0.2)(N, 4 * C).to(float)), 'rhat': _w(rhat), 'e_attr': _w((lambda *s: torch.randn(*s, dtype=torch.bfloat16) * 0.2)(E, De).to(float)), 'src': _w(src), 'dst': _w(dst), 'w_rad': _w((lambda *s: torch.randn(*s, dtype=torch.bfloat16) * 0.2)(De, 5 * C).to(float)), 'w_si0': _w((lambda *s: torch.randn(*s, dtype=torch.bfloat16) * 0.2)(2 * C, C).to(float)), 'w_si1': _w((lambda *s: torch.randn(*s, dtype=torch.bfloat16) * 0.05)(3 * C, C).to(float)), 'cg_eps': _w(eps)}

def reference(x, rhat, e_attr, src, dst, w_rad, w_si0, w_si1, cg_eps):
    N = x.shape[0]
    C = w_si0.shape[1]
    E = rhat.shape[0]
    x0 = x[:, :C].clone()
    x1 = x[:, C:].reshape(N, 3, C)
    R = (e_attr @ w_rad).reshape(E, 5, C)
    f0 = x0[src]
    f1 = x1[src]
    Y1 = rhat
    p00_0 = f0 * R[:, 0, :]
    p11_0 = torch.einsum('ejc,ej->ec', f1, Y1) * R[:, 1, :]
    p01_1 = torch.einsum('ec,ej->ejc', f0, Y1) * R[:, 2, :][:, None, :]
    p10_1 = f1 * R[:, 3, :][:, None, :]
    p11_1 = torch.einsum('ijk,ekc,ej->eic', cg_eps, f1, Y1) * R[:, 4, :][:, None, :]
    m0 = torch.concatenate([p00_0, p11_0], axis=-1) @ w_si0
    m1 = torch.einsum('ejp,pc->ejc', torch.concatenate([p01_1, p10_1, p11_1], axis=-1), w_si1)
    agg0 = _segment_sum(m0, dst, N)
    agg1 = _segment_sum(m1.reshape(E, 3 * C), dst, N).reshape(N, 3, C)
    gate = _sigmoid(agg0)
    out1 = agg1 * gate[:, None, :]
    return torch.concatenate([agg0, out1.reshape(N, 3 * C)], axis=-1)
```

```asm
; @launch grid=(256,1,1) block=(512,1,1) lds=160864
.amdgcn_target "amdgcn-amd-amdhsa--gfx950"
.text
.globl gather_scatter__tensor_product_equiv_equiformer__graph_kernel
.p2align 8
.type gather_scatter__tensor_product_equiv_equiformer__graph_kernel,@function
gather_scatter__tensor_product_equiv_equiformer__graph_kernel:
    s_cmp_ge_u32 s2, 256
    s_cbranch_scc1 K2_END
    s_load_dwordx16 s[72:87], s[0:1], 0
    s_load_dwordx4 s[88:91], s[0:1], 72
    s_load_dwordx2 s[92:93], s[0:1], 88
    s_memrealtime s[46:47]
    v_lshrrev_b32 v1, 6, v0
    v_and_b32 v175, 63, v0
    s_and_b32 s24, s2, 7
    v_readfirstlane_b32 s3, v1
    s_lshl_b32 s24, s24, 5
    s_lshr_b32 s44, s2, 3
    s_add_u32 s24, s24, s44
    s_mul_i32 s44, s24, 49
    s_sub_u32 s44, 12500, s44
    s_min_u32 s25, s44, 49
    v_lshlrev_b32 v12, 4, v0
    v_mul_u32_u24 v13, 24, v0
    v_mov_b32 v15, 0
    s_add_u32 s45, s2, s3
    s_waitcnt lgkmcnt(0)
    s_mov_b32 s68, s90
    s_and_b32 s69, s91, 0xffff
    s_mov_b32 s70, 256
    s_mov_b32 s71, 0x20000
    s_cmp_lg_u32 s45, 0
    s_cbranch_scc1 P1_NONONCE
    s_or_b32 s46, s46, 1
    v_mov_b32 v14, s46
    s_mov_b64 exec, 1
    buffer_atomic_cmpswap v[14:15], v15, s[68:71], 0 offen sc1
    s_mov_b64 exec, -1
P1_NONONCE:
    s_mov_b32 s16, s92
    s_and_b32 s17, s93, 0xffff
    s_mov_b32 s18, 26962944
    s_mov_b32 s19, 0x20000
    s_cmp_ge_u32 s2, 250
    s_cbranch_scc1 P1_PREPLD
    s_mov_b32 s64, s80
    s_and_b32 s65, s81, 0xffff
    s_mov_b32 s66, 3200000
    s_mov_b32 s67, 0x20000
    s_mov_b32 s60, s78
    s_and_b32 s61, s79, 0xffff
    s_mov_b32 s62, 3200000
    s_mov_b32 s63, 0x20000
    s_mov_b32 s56, s74
    s_and_b32 s57, s75, 0xffff
    s_mov_b32 s58, 4800000
    s_mov_b32 s59, 0x20000
    s_mul_i32 s44, s2, 12800
    s_mul_i32 s45, s2, 19200
    v_cmp_gt_u32 vcc, 400, v0
    s_add_u32 s46, s44, 6400
    s_add_u32 s47, s45, 9600
    s_mov_b64 s[54:55], vcc
    s_mov_b64 exec, vcc
    buffer_load_dwordx4 v[16:19], v12, s[64:67], s44 offen
    buffer_load_dwordx4 v[56:59], v12, s[64:67], s46 offen
    s_mov_b64 exec, -1
    v_lshlrev_b32 v1, 2, v0
    v_add_u32 v1, 129632, v1
    ds_write_b32 v1, v15
    s_waitcnt lgkmcnt(0)
    s_barrier
    s_mov_b64 exec, s[54:55]
    buffer_load_dwordx4 v[20:23], v12, s[60:63], s44 offen
    buffer_load_dwordx4 v[24:27], v13, s[56:59], s45 offen
    buffer_load_dwordx2 v[28:29], v13, s[56:59], s45 offen offset:16
    buffer_load_dwordx4 v[60:63], v12, s[60:63], s46 offen
    buffer_load_dwordx4 v[64:67], v13, s[56:59], s47 offen
    buffer_load_dwordx2 v[68:69], v13, s[56:59], s47 offen offset:16
    s_mov_b64 exec, -1
    s_branch P1_COMMON
P1_PREPLD:
    s_cmp_lg_u32 s2, 250
    s_cbranch_scc1 P1_FRAG
    s_mov_b32 s56, s82
    s_and_b32 s57, s83, 0xffff
    s_mov_b32 s58, 10240
    s_mov_b32 s59, 0x20000
    v_lshrrev_b32 v4, 5, v175
    v_mul_u32_u24 v4, 2560, v4
    v_and_b32 v5, 31, v175
    v_lshl_add_u32 v4, v5, 1, v4
    v_lshlrev_b32 v7, 4, v175
    s_add_u32 s44, s3, 0
    s_min_u32 s44, s44, 19
    s_and_b32 s45, s44, 1
    s_lshr_b32 s46, s44, 1
    s_mul_i32 s45, s45, 5120
    s_lshl_b32 s46, s46, 6
    s_add_u32 s45, s45, s46
    s_lshl_b32 s60, s44, 10
    s_add_u32 s60, s60, 26377216
    buffer_load_ushort v16, v4, s[56:59], s45 offen offset:0
    buffer_load_ushort v17, v4, s[56:59], s45 offen offset:640
    buffer_load_ushort v18, v4, s[56:59], s45 offen offset:1280
    buffer_load_ushort v19, v4, s[56:59], s45 offen offset:1920
    s_add_u32 s44, s3, 8
    s_min_u32 s44, s44, 19
    s_and_b32 s45, s44, 1
    s_lshr_b32 s46, s44, 1
    s_mul_i32 s45, s45, 5120
    s_lshl_b32 s46, s46, 6
    s_add_u32 s45, s45, s46
    s_lshl_b32 s61, s44, 10
    s_add_u32 s61, s61, 26377216
    buffer_load_ushort v20, v4, s[56:59], s45 offen offset:0
    buffer_load_ushort v21, v4, s[56:59], s45 offen offset:640
    buffer_load_ushort v22, v4, s[56:59], s45 offen offset:1280
    buffer_load_ushort v23, v4, s[56:59], s45 offen offset:1920
    s_add_u32 s44, s3, 16
    s_min_u32 s44, s44, 19
    s_and_b32 s45, s44, 1
    s_lshr_b32 s46, s44, 1
    s_mul_i32 s45, s45, 5120
    s_lshl_b32 s46, s46, 6
    s_add_u32 s45, s45, s46
    s_lshl_b32 s62, s44, 10
    s_add_u32 s62, s62, 26377216
    buffer_load_ushort v24, v4, s[56:59], s45 offen offset:0
    buffer_load_ushort v25, v4, s[56:59], s45 offen offset:640
    buffer_load_ushort v26, v4, s[56:59], s45 offen offset:1280
    buffer_load_ushort v27, v4, s[56:59], s45 offen offset:1920
    s_waitcnt vmcnt(8)
    v_lshlrev_b32 v16, 16, v16
    v_lshlrev_b32 v17, 16, v17
    v_lshlrev_b32 v18, 16, v18
    v_lshlrev_b32 v19, 16, v19
    buffer_store_dwordx4 v[16:19], v7, s[16:19], s60 offen sc1
    s_waitcnt vmcnt(5)
    v_lshlrev_b32 v20, 16, v20
    v_lshlrev_b32 v21, 16, v21
    v_lshlrev_b32 v22, 16, v22
    v_lshlrev_b32 v23, 16, v23
    buffer_store_dwordx4 v[20:23], v7, s[16:19], s61 offen sc1
    s_waitcnt vmcnt(2)
    v_lshlrev_b32 v24, 16, v24
    v_lshlrev_b32 v25, 16, v25
    v_lshlrev_b32 v26, 16, v26
    v_lshlrev_b32 v27, 16, v27
    buffer_store_dwordx4 v[24:27], v7, s[16:19], s62 offen sc1
    s_branch P1_COMMON
P1_FRAG:
    s_mov_b32 s56, s84
    s_and_b32 s57, s85, 0xffff
    s_mov_b32 s58, 16384
    s_mov_b32 s59, 0x20000
    s_mov_b32 s60, s86
    s_and_b32 s61, s87, 0xffff
    s_mov_b32 s62, 24576
    s_mov_b32 s63, 0x20000
    s_sub_u32 s44, s2, 251
    s_lshl_b32 s44, s44, 3
    s_add_u32 s44, s44, s3
    s_cmp_ge_u32 s44, 20
    s_cselect_b32 s45, 20, 0
    s_cselect_b32 s46, 64, 0
    s_sub_u32 s45, s44, s45
    v_bfe_u32 v4, v175, 2, 1
    v_bfe_u32 v5, v175, 3, 2
    v_and_b32 v6, 3, v175
    v_lshlrev_b32 v4, 4, v4
    v_lshl_add_u32 v4, v5, 2, v4
    v_add_u32 v4, v4, v6
    v_lshl_add_u32 v4, v4, 1, s46
    v_lshrrev_b32 v5, 5, v175
    s_lshl_b32 s64, s44, 10
    s_add_u32 s64, s64, 26397696
    v_lshlrev_b32 v7, 4, v175
    s_cmp_ge_u32 s45, 16
    s_cbranch_scc1 P1_FRAGC
    v_lshl_add_u32 v4, v5, 9, v4
    s_and_b32 s46, s45, 7
    s_lshl_b32 s46, s46, 10
    s_add_u32 s47, s46, 8192
    s_cmp_ge_u32 s45, 8
    s_cbranch_scc1 P1_FRAGB
    buffer_load_ushort v16, v4, s[56:59], s46 offen offset:0
    buffer_load_ushort v20, v4, s[56:59], s47 offen offset:0
    buffer_load_ushort v17, v4, s[56:59], s46 offen offset:128
    buffer_load_ushort v21, v4, s[56:59], s47 offen offset:128
    buffer_load_ushort v18, v4, s[56:59], s46 offen offset:256
    buffer_load_ushort v22, v4, s[56:59], s47 offen offset:256
    buffer_load_ushort v19, v4, s[56:59], s46 offen offset:384
    buffer_load_ushort v23, v4, s[56:59], s47 offen offset:384
    s_branch P1_FRAGST
P1_FRAGB:
    buffer_load_ushort v16, v4, s[60:63], s46 offen offset:0
    buffer_load_ushort v20, v4, s[60:63], s47 offen offset:0
    buffer_load_ushort v17, v4, s[60:63], s46 offen offset:128
    buffer_load_ushort v21, v4, s[60:63], s47 offen offset:128
    buffer_load_ushort v18, v4, s[60:63], s46 offen offset:256
    buffer_load_ushort v22, v4, s[60:63], s47 offen offset:256
    buffer_load_ushort v19, v4, s[60:63], s46 offen offset:384
    buffer_load_ushort v23, v4, s[60:63], s47 offen offset:384
    s_branch P1_FRAGST
P1_FRAGC:
    v_lshl_add_u32 v4, v5, 10, v4
    s_sub_u32 s46, s45, 16
    s_lshl_b32 s46, s46, 11
    s_add_u32 s46, s46, 16384
    buffer_load_ushort v16, v4, s[60:63], s46 offen offset:0
    buffer_load_ushort v20, v4, s[60:63], s46 offen offset:128
    buffer_load_ushort v17, v4, s[60:63], s46 offen offset:256
    buffer_load_ushort v21, v4, s[60:63], s46 offen offset:384
    buffer_load_ushort v18, v4, s[60:63], s46 offen offset:512
    buffer_load_ushort v22, v4, s[60:63], s46 offen offset:640
    buffer_load_ushort v19, v4, s[60:63], s46 offen offset:768
    buffer_load_ushort v23, v4, s[60:63], s46 offen offset:896
P1_FRAGST:
    s_waitcnt vmcnt(0)
    v_lshl_or_b32 v16, v20, 16, v16
    v_lshl_or_b32 v17, v21, 16, v17
    v_lshl_or_b32 v18, v22, 16, v18
    v_lshl_or_b32 v19, v23, 16, v19
    buffer_store_dwordx4 v[16:19], v7, s[16:19], s64 offen sc1
P1_COMMON:
    buffer_load_dword v14, v15, s[68:71], 0 offen sc1
    s_sub_u32 s8, s72, 3072
    s_subb_u32 s9, s73, 0
    s_and_b32 s9, s9, 0xffff
    s_mov_b32 s10, 6403072
    s_mov_b32 s11, 0x20000
    s_mov_b32 s12, s76
    s_and_b32 s13, s77, 0xffff
    s_mov_b32 s14, 25600000
    s_mov_b32 s15, 0x20000
    s_mov_b32 s20, s88
    s_and_b32 s21, s89, 0xffff
    s_mov_b32 s22, 6400000
    s_mov_b32 s23, 0x20000
    s_mov_b32 s90, 132192
    s_mov_b32 s26, 0
    s_mov_b32 s27, 250
    s_mov_b32 s28, 0
    s_mov_b32 s29, 0
    s_mov_b32 s30, 1
    v_mov_b32 v112, 0
    v_mov_b32 v114, 0
    s_cmp_ge_u32 s2, 250
    s_cbranch_scc1 P1_PUBLISH
    s_mul_i32 s44, s2, 102400
    s_mov_b32 s45, 129632
    v_mov_b32 v1, 1
    v_lshl_add_u32 v2, v0, 7, s44
    s_mov_b32 s46, 0x05040100
    s_mov_b32 s47, 0x05040302
    s_mov_b64 exec, s[54:55]
    s_waitcnt vmcnt(8)
    v_mul_u32_u24 v30, 21400, v16
    v_mul_u32_u24 v31, 21400, v17
    v_mul_u32_u24 v32, 21400, v18
    v_mul_u32_u24 v33, 21400, v19
    v_lshrrev_b32 v30, 20, v30
    v_lshrrev_b32 v31, 20, v31
    v_lshrrev_b32 v32, 20, v32
    v_lshrrev_b32 v33, 20, v33
    v_mul_u32_u24 v38, 49, v30
    v_mul_u32_u24 v39, 49, v31
    v_mul_u32_u24 v40, 49, v32
    v_mul_u32_u24 v41, 49, v33
    v_lshl_add_u32 v30, v30, 2, s45
    v_lshl_add_u32 v31, v31, 2, s45
    v_lshl_add_u32 v32, v32, 2, s45
    v_lshl_add_u32 v33, v33, 2, s45
    ds_add_rtn_u32 v34, v30, v1
    ds_add_rtn_u32 v35, v31, v1
    ds_add_rtn_u32 v36, v32, v1
    ds_add_rtn_u32 v37, v33, v1
    s_waitcnt vmcnt(7)
    v_mul_u32_u24 v70, 21400, v56
    v_mul_u32_u24 v71, 21400, v57
    v_mul_u32_u24 v72, 21400, v58
    v_mul_u32_u24 v73, 21400, v59
    v_lshrrev_b32 v70, 20, v70
    v_lshrrev_b32 v71, 20, v71
    v_lshrrev_b32 v72, 20, v72
    v_lshrrev_b32 v73, 20, v73
    v_mul_u32_u24 v78, 49, v70
    v_mul_u32_u24 v79, 49, v71
    v_mul_u32_u24 v80, 49, v72
    v_mul_u32_u24 v81, 49, v73
    v_lshl_add_u32 v70, v70, 2, s45
    v_lshl_add_u32 v71, v71, 2, s45
    v_lshl_add_u32 v72, v72, 2, s45
    v_lshl_add_u32 v73, v73, 2, s45
    ds_add_rtn_u32 v74, v70, v1
    ds_add_rtn_u32 v75, v71, v1
    ds_add_rtn_u32 v76, v72, v1
    ds_add_rtn_u32 v77, v73, v1
    v_sub_u32 v38, v16, v38
    v_sub_u32 v39, v17, v39
    v_sub_u32 v40, v18, v40
    v_sub_u32 v41, v19, v41
    v_add_u32 v42, 0, v2
    v_add_u32 v43, 32, v2
    v_add_u32 v44, 64, v2
    v_add_u32 v45, 96, v2
    v_lshl_or_b32 v38, v38, 26, v42
    v_lshl_or_b32 v39, v39, 26, v43
    v_lshl_or_b32 v40, v40, 26, v44
    v_lshl_or_b32 v41, v41, 26, v45
    v_sub_u32 v78, v56, v78
    v_sub_u32 v79, v57, v79
    v_sub_u32 v80, v58, v80
    v_sub_u32 v81, v59, v81
    v_add_u32 v82, 51200, v2
    v_add_u32 v83, 51232, v2
    v_add_u32 v84, 51264, v2
    v_add_u32 v85, 51296, v2
    v_lshl_or_b32 v78, v78, 26, v82
    v_lshl_or_b32 v79, v79, 26, v83
    v_lshl_or_b32 v80, v80, 26, v84
    v_lshl_or_b32 v81, v81, 26, v85
    s_mov_b64 exec, -1
    v_lshl_add_u32 v3, v175, 4, s45
    s_waitcnt lgkmcnt(0)
    s_barrier
    ds_read_b128 v[96:99], v3
    s_mov_b32 s44, 91232
    s_waitcnt lgkmcnt(0)
    v_add_u32 v100, v96, v97
    v_add_u32 v101, v100, v98
    v_add_u32 v102, v101, v99
    v_mov_b32 v103, v102
    s_nop 1
    v_add_u32_dpp v103, v103, v103 row_shr:1 row_mask:0xf bank_mask:0xf
    s_nop 1
    v_add_u32_dpp v103, v103, v103 row_shr:2 row_mask:0xf bank_mask:0xf
    s_nop 1
    v_add_u32_dpp v103, v103, v103 row_shr:4 row_mask:0xf bank_mask:0xf
    s_nop 1
    v_add_u32_dpp v103, v103, v103 row_shr:8 row_mask:0xf bank_mask:0xf
    s_nop 1
    v_add_u32_dpp v103, v103, v103 row_bcast:15 row_mask:0xa bank_mask:0xf
    s_nop 1
    v_add_u32_dpp v103, v103, v103 row_bcast:31 row_mask:0xc bank_mask:0xf
    v_sub_u32 v104, v103, v102
    v_add_u32 v105, v104, v96
    v_add_u32 v106, v104, v100
    v_add_u32 v107, v104, v101
    ds_write_b128 v3, v[104:107] offset:1024
    s_mov_b64 exec, s[54:55]
    ds_read_b32 v16, v30 offset:1024
    ds_read_b32 v17, v31 offset:1024
    ds_read_b32 v18, v32 offset:1024
    ds_read_b32 v19, v33 offset:1024
    ds_read_b32 v56, v70 offset:1024
    ds_read_b32 v57, v71 offset:1024
    ds_read_b32 v58, v72 offset:1024
    ds_read_b32 v59, v73 offset:1024
    s_waitcnt lgkmcnt(4)
    v_add_u32 v16, v16, v34
    v_add_u32 v17, v17, v35
    v_add_u32 v18, v18, v36
    v_add_u32 v19, v19, v37
    v_mad_u32_u24 v16, v16, 12, s44
    v_mad_u32_u24 v17, v17, 12, s44
    v_mad_u32_u24 v18, v18, 12, s44
    v_mad_u32_u24 v19, v19, 12, s44
    s_waitcnt vmcnt(4)
    v_alignbit_b32 v43, v26, v25, 16
    v_alignbit_b32 v45, v29, v28, 16
    v_perm_b32 v46, v20, v25, s46
    v_perm_b32 v47, v21, v26, s47
    v_perm_b32 v48, v22, v28, s46
    v_perm_b32 v49, v23, v29, s47
    v_mov_b32 v42, v24
    v_mov_b32 v44, v27
    v_xor_b32 v46, 0x8000, v46
    v_xor_b32 v47, 0x8000, v47
    v_xor_b32 v48, 0x8000, v48
    v_xor_b32 v49, 0x8000, v49
    ds_write2_b32 v16, v42, v46 offset0:0 offset1:1
    ds_write_b32 v16, v38 offset:8
    ds_write2_b32 v17, v43, v47 offset0:0 offset1:1
    ds_write_b32 v17, v39 offset:8
    ds_write2_b32 v18, v44, v48 offset0:0 offset1:1
    ds_write_b32 v18, v40 offset:8
    ds_write2_b32 v19, v45, v49 offset0:0 offset1:1
    ds_write_b32 v19, v41 offset:8
    s_waitcnt lgkmcnt(8)
    v_add_u32 v56, v56, v74
    v_add_u32 v57, v57, v75
    v_add_u32 v58, v58, v76
    v_add_u32 v59, v59, v77
    v_mad_u32_u24 v56, v56, 12, s44
    v_mad_u32_u24 v57, v57, 12, s44
    v_mad_u32_u24 v58, v58, 12, s44
    v_mad_u32_u24 v59, v59, 12, s44
    s_waitcnt vmcnt(1)
    v_alignbit_b32 v83, v66, v65, 16
    v_alignbit_b32 v85, v69, v68, 16
    v_perm_b32 v86, v60, v65, s46
    v_perm_b32 v87, v61, v66, s47
    v_perm_b32 v88, v62, v68, s46
    v_perm_b32 v89, v63, v69, s47
    v_mov_b32 v82, v64
    v_mov_b32 v84, v67
    v_xor_b32 v86, 0x8000, v86
    v_xor_b32 v87, 0x8000, v87
    v_xor_b32 v88, 0x8000, v88
    v_xor_b32 v89, 0x8000, v89
    ds_write2_b32 v56, v82, v86 offset0:0 offset1:1
    ds_write_b32 v56, v78 offset:8
    ds_write2_b32 v57, v83, v87 offset0:0 offset1:1
    ds_write_b32 v57, v79 offset:8
    ds_write2_b32 v58, v84, v88 offset0:0 offset1:1
    ds_write_b32 v58, v80 offset:8
    ds_write2_b32 v59, v85, v89 offset0:0 offset1:1
    ds_write_b32 v59, v81 offset:8
    s_mov_b64 exec, -1
    v_add_u32 v3, s44, v12
    s_mul_i32 s44, s2, 38400
    s_add_u32 s44, s44, 16777216
    v_cmp_gt_u32 vcc, 352, v0
    s_waitcnt lgkmcnt(0)
    s_barrier
    v_lshl_add_u32 v100, v0, 3, s45
    ds_read_b64 v[96:97], v100
    ds_read_b64 v[98:99], v100 offset:1024
    ds_read_b128 v[144:147], v3 offset:0
    ds_read_b128 v[148:151], v3 offset:8192
    ds_read_b128 v[152:155], v3 offset:16384
    ds_read_b128 v[156:159], v3 offset:24576
    ds_read_b128 v[160:163], v3 offset:32768
    s_waitcnt lgkmcnt(4)
    v_lshl_or_b32 v112, v96, 16, v98
    v_lshl_or_b32 v114, v97, 16, v99
    buffer_store_dwordx4 v[144:147], v12, s[16:19], s44 offen sc1
    s_add_u32 s44, s44, 8192
    s_waitcnt lgkmcnt(3)
    buffer_store_dwordx4 v[148:151], v12, s[16:19], s44 offen sc1
    s_add_u32 s44, s44, 8192
    s_waitcnt lgkmcnt(2)
    buffer_store_dwordx4 v[152:155], v12, s[16:19], s44 offen sc1
    s_add_u32 s44, s44, 8192
    s_waitcnt lgkmcnt(1)
    buffer_store_dwordx4 v[156:159], v12, s[16:19], s44 offen sc1
    s_add_u32 s44, s44, 8192
    s_waitcnt lgkmcnt(0)
    s_mov_b64 exec, vcc
    buffer_store_dwordx4 v[160:163], v12, s[16:19], s44 offen sc1
    s_mov_b64 exec, -1
P1_PUBLISH:
P1_WALL:
    s_waitcnt vmcnt(0)
P1_WDONE:
    s_movk_i32 s45, 0x7fff
P1_NONCE:
    v_readfirstlane_b32 s91, v14
    s_sub_u32 s45, s45, 1
    s_cbranch_scc1 P1_GOT
    s_cmp_lg_u32 s91, 0
    s_cbranch_scc1 P1_GOT
    buffer_load_dword v14, v15, s[68:71], 0 offen sc1
    s_waitcnt vmcnt(0)
    s_branch P1_NONCE
P1_GOT:
    s_waitcnt lgkmcnt(0)
    s_barrier
    s_cmp_ge_u32 s3, 2
    s_cbranch_scc1 P1_END
    v_mov_b32 v113, s91
    v_mov_b32 v115, s91
    s_lshl_b32 s44, s2, 11
    s_add_u32 s44, s44, 26438656
    buffer_store_dwordx4 v[112:115], v12, s[16:19], s44 offen sc1
P1_END:
    s_lshl_b32 s44, s3, 10
    v_lshl_add_u32 v2, v175, 4, s44
    v_mov_b32 v8, 0x3f803f80
    v_mov_b32 v9, v8
    v_mov_b32 v10, v8
    v_mov_b32 v11, v8
    v_add_u32 v3, 32768, v2
    v_lshrrev_b32 v6, 2, v2
    v_add_u32 v6, s90, v6
    v_mov_b32 v5, 0
    v_mov_b32 v4, 0
    ds_write_b32 v6, v5
    ds_write_b32 v6, v5 offset:2048
    ds_write_b64 v5, v[4:5] offset:0
    ds_write_b128 v2, v[8:11] offset:16
    ds_write_b128 v2, v[8:11] offset:8208
    ds_write_b128 v2, v[8:11] offset:16400
    ds_write_b128 v2, v[8:11] offset:24592
    ds_write_b128 v3, v[8:11] offset:16
    ds_write_b128 v3, v[8:11] offset:8208
    ds_write_b128 v3, v[8:11] offset:16400
    ds_write_b128 v3, v[8:11] offset:24592
    v_cmp_gt_u32 vcc, 5200, v2
    s_mov_b64 exec, vcc
    ds_write_b128 v3, v[8:11] offset:32784
    s_mov_b64 exec, -1
    s_and_b32 s44, s3, 1
    s_lshl_b32 s45, s44, 3
    s_lshl_b32 s50, 0x00ff00ff, s45
    s_mov_b32 s51, s50
    s_mov_b32 s52, 0x03ffffff
    s_mul_i32 s42, s3, 8192
    s_add_u32 s42, s42, 91232
    s_add_u32 s4, s42, 4096
    s_lshr_b32 s43, s3, 1
    s_lshl_b32 s43, s43, 10
    s_add_u32 s43, s43, 156768
    s_lshl_b32 s44, s44, 7
    s_add_u32 s44, s44, s43
    s_movk_i32 s5, 3072
    s_movk_i32 s6, 2048
    s_movk_i32 s7, 1024
    s_movk_i32 s94, 3328
    s_movk_i32 s95, 2304
    s_movk_i32 s96, 1280
    s_movk_i32 s97, 256
    v_lshrrev_b32 v1, 5, v175
    v_bfe_u32 v2, v175, 4, 1
    v_lshrrev_b32 v4, 4, v175
    v_bfe_u32 v5, v175, 2, 2
    v_and_b32 v6, 3, v175
    v_lshlrev_b32 v7, 10, v1
    v_lshl_add_u32 v7, v5, 8, v7
    v_lshl_add_u32 v7, v2, 5, v7
    v_lshl_add_u32 v7, v6, 3, v7
    v_add_u32 v7, s42, v7
    v_lshl_add_u32 v237, v5, 6, v7
    v_xor_b32 v3, 1, v5
    v_lshl_add_u32 v238, v3, 6, v7
    v_xor_b32 v3, 2, v5
    v_lshl_add_u32 v239, v3, 6, v7
    v_xor_b32 v3, 3, v5
    v_lshl_add_u32 v240, v3, 6, v7
    v_bfe_u32 v7, v175, 3, 1
    v_lshl_add_u32 v7, v1, 1, v7
    v_lshlrev_b32 v7, 8, v7
    v_and_b32 v3, 7, v175
    v_lshl_add_u32 v7, v3, 1, v7
    v_add_u32 v241, s44, v7
    v_bfe_u32 v7, v175, 2, 1
    v_lshl_add_u32 v7, v7, 1, v1
    v_lshl_add_u32 v7, v7, 2, v6
    v_lshlrev_b32 v242, 2, v7
    v_lshl_add_u32 v7, v6, 2, v4
    v_lshl_add_u32 v243, v7, 2, 64
    v_and_b32 v6, 15, v175
    v_lshlrev_b32 v3, 2, v4
    v_xor_b32 v7, v6, v3
    v_lshlrev_b32 v244, 4, v7
    v_lshlrev_b32 v245, 4, v2
    v_mul_u32_u24 v7, 0x8000, v2
    v_lshl_or_b32 v246, v7, 16, v7
    s_branch K2_POLL
K2_WIN:
    v_mbcnt_lo_u32_b32 v175, -1, 0
    v_mbcnt_hi_u32_b32 v175, -1, v175
    s_lshl_b32 s44, s3, 10
    v_lshl_add_u32 v2, v175, 4, s44
    v_mov_b32 v8, 0x3f803f80
    v_mov_b32 v9, v8
    v_mov_b32 v10, v8
    v_mov_b32 v11, v8
    v_add_u32 v3, 32768, v2
    v_lshrrev_b32 v6, 2, v2
    v_add_u32 v6, s90, v6
    v_mov_b32 v5, 0
    v_mov_b32 v4, 0
    ds_write_b32 v6, v5
    ds_write_b32 v6, v5 offset:2048
    ds_write_b64 v5, v[4:5] offset:0
    ds_write_b128 v2, v[8:11] offset:16
    ds_write_b128 v2, v[8:11] offset:8208
    ds_write_b128 v2, v[8:11] offset:16400
    ds_write_b128 v2, v[8:11] offset:24592
    ds_write_b128 v3, v[8:11] offset:16
    ds_write_b128 v3, v[8:11] offset:8208
    ds_write_b128 v3, v[8:11] offset:16400
    ds_write_b128 v3, v[8:11] offset:24592
    v_cmp_gt_u32 vcc, 5200, v2
    s_mov_b64 exec, vcc
    ds_write_b128 v3, v[8:11] offset:32784
    s_mov_b64 exec, -1
    s_waitcnt lgkmcnt(0)
    s_barrier
K2_POLL:
    v_lshrrev_b32 v4, 4, v175
    v_lshlrev_b32 v3, 11, v4
    s_lshl_b32 s45, s3, 2
    v_add_u32 v4, s45, v4
    v_and_b32 v6, 15, v175
    v_mul_u32_u24 v5, 38400, v4
    v_mad_u32_u24 v5, v6, 12, v5
    v_add_u32 v1, 16, v6
    v_mov_b32 v9, 0
    v_mov_b32 v2, 1
    s_lshl_b32 s45, s3, 13
    s_lshl_b32 s46, s24, 3
    s_add_u32 s45, s45, s46
    s_add_u32 s45, s45, 26438656
    s_movk_i32 s47, 0x7fff
    s_mov_b32 s31, 1
    s_mov_b32 s44, s45
    buffer_load_dwordx2 v[12:13], v3, s[16:19], s44 offen sc1
    s_add_u32 s44, s44, 65536
    buffer_load_dwordx2 v[14:15], v3, s[16:19], s44 offen sc1
    s_add_u32 s44, s44, 65536
    buffer_load_dwordx2 v[16:17], v3, s[16:19], s44 offen sc1
    s_add_u32 s44, s44, 65536
    buffer_load_dwordx2 v[18:19], v3, s[16:19], s44 offen sc1
    s_add_u32 s44, s44, 65536
    buffer_load_dwordx2 v[20:21], v3, s[16:19], s44 offen sc1
    s_add_u32 s44, s44, 65536
    buffer_load_dwordx2 v[22:23], v3, s[16:19], s44 offen sc1
    s_add_u32 s44, s44, 65536
    buffer_load_dwordx2 v[24:25], v3, s[16:19], s44 offen sc1
    s_add_u32 s44, s44, 65536
    buffer_load_dwordx2 v[26:27], v3, s[16:19], s44 offen sc1
    s_cmp_eq_u32 s27, 250
    s_cbranch_scc1 K2_WHOLE
    s_lshl_b32 s44, s26, 11
    s_add_u32 s44, s44, s46
    s_add_u32 s44, s44, 26438656
    s_buffer_load_dword s46, s[16:19], s44
    s_add_u32 s47, s28, 112
    s_add_u32 s32, s26, s27
    s_mov_b32 s33, 0
    s_mov_b32 s34, 0
    s_waitcnt lgkmcnt(0)
    s_lshr_b32 s46, s46, 16
    s_cmp_eq_u32 s29, 0
    s_cbranch_scc1 K2_NOSUB
    s_cmp_ge_u32 s47, s46
    s_cbranch_scc1 K2_SUBSET
    s_mov_b32 s32, s26
    s_mov_b32 s33, s47
    s_mov_b32 s34, 1
    s_branch K2_SUBSET
K2_NOSUB:
    s_mov_b32 s47, 0xffff
K2_SUBSET:
    s_cmp_ge_u32 s32, 250
    s_cselect_b32 s31, 1, 0
    s_waitcnt vmcnt(0)
    v_lshrrev_b32 v7, 16, v12
    v_subrev_u32 v8, s26, v4
    v_min_u32 v7, s47, v7
    v_cmp_gt_u32 vcc, s27, v8
    v_subrev_u32 v7, s28, v7
    v_and_b32 v8, 0xffff, v12
    v_max_i32 v7, 0, v7
    v_add_u32 v8, s28, v8
    v_cndmask_b32 v7, 0, v7, vcc
    v_add_u32 v4, 32, v4
    v_lshl_or_b32 v12, v7, 16, v8
    v_lshrrev_b32 v7, 16, v14
    v_subrev_u32 v8, s26, v4
    v_min_u32 v7, s47, v7
    v_cmp_gt_u32 vcc, s27, v8
    v_subrev_u32 v7, s28, v7
    v_and_b32 v8, 0xffff, v14
    v_max_i32 v7, 0, v7
    v_add_u32 v8, s28, v8
    v_cndmask_b32 v7, 0, v7, vcc
    v_add_u32 v4, 32, v4
    v_lshl_or_b32 v14, v7, 16, v8
    v_lshrrev_b32 v7, 16, v16
    v_subrev_u32 v8, s26, v4
    v_min_u32 v7, s47, v7
    v_cmp_gt_u32 vcc, s27, v8
    v_subrev_u32 v7, s28, v7
    v_and_b32 v8, 0xffff, v16
    v_max_i32 v7, 0, v7
    v_add_u32 v8, s28, v8
    v_cndmask_b32 v7, 0, v7, vcc
    v_add_u32 v4, 32, v4
    v_lshl_or_b32 v16, v7, 16, v8
    v_lshrrev_b32 v7, 16, v18
    v_subrev_u32 v8, s26, v4
    v_min_u32 v7, s47, v7
    v_cmp_gt_u32 vcc, s27, v8
    v_subrev_u32 v7, s28, v7
    v_and_b32 v8, 0xffff, v18
    v_max_i32 v7, 0, v7
    v_add_u32 v8, s28, v8
    v_cndmask_b32 v7, 0, v7, vcc
    v_add_u32 v4, 32, v4
    v_lshl_or_b32 v18, v7, 16, v8
    v_lshrrev_b32 v7, 16, v20
    v_subrev_u32 v8, s26, v4
    v_min_u32 v7, s47, v7
    v_cmp_gt_u32 vcc, s27, v8
    v_subrev_u32 v7, s28, v7
    v_and_b32 v8, 0xffff, v20
    v_max_i32 v7, 0, v7
    v_add_u32 v8, s28, v8
    v_cndmask_b32 v7, 0, v7, vcc
    v_add_u32 v4, 32, v4
    v_lshl_or_b32 v20, v7, 16, v8
    v_lshrrev_b32 v7, 16, v22
    v_subrev_u32 v8, s26, v4
    v_min_u32 v7, s47, v7
    v_cmp_gt_u32 vcc, s27, v8
    v_subrev_u32 v7, s28, v7
    v_and_b32 v8, 0xffff, v22
    v_max_i32 v7, 0, v7
    v_add_u32 v8, s28, v8
    v_cndmask_b32 v7, 0, v7, vcc
    v_add_u32 v4, 32, v4
    v_lshl_or_b32 v22, v7, 16, v8
    v_lshrrev_b32 v7, 16, v24
    v_subrev_u32 v8, s26, v4
    v_min_u32 v7, s47, v7
    v_cmp_gt_u32 vcc, s27, v8
    v_subrev_u32 v7, s28, v7
    v_and_b32 v8, 0xffff, v24
    v_max_i32 v7, 0, v7
    v_add_u32 v8, s28, v8
    v_cndmask_b32 v7, 0, v7, vcc
    v_add_u32 v4, 32, v4
    v_lshl_or_b32 v24, v7, 16, v8
    v_lshrrev_b32 v7, 16, v26
    v_subrev_u32 v8, s26, v4
    v_min_u32 v7, s47, v7
    v_cmp_gt_u32 vcc, s27, v8
    v_subrev_u32 v7, s28, v7
    v_and_b32 v8, 0xffff, v26
    v_max_i32 v7, 0, v7
    v_add_u32 v8, s28, v8
    v_cndmask_b32 v7, 0, v7, vcc
    v_add_u32 v4, 32, v4
    v_lshl_or_b32 v26, v7, 16, v8
    s_mov_b32 s47, 0
K2_WHOLE:
    s_mov_b32 s46, 16777216
    s_waitcnt vmcnt(0)
K2_CK0:
    v_cmp_ne_u32 vcc, s91, v13
    v_cmp_lt_u32_sdwa s[54:55], v6, v12 src0_sel:DWORD src1_sel:WORD_1
    v_cmp_lt_u32_sdwa s[56:57], v1, v12 src0_sel:DWORD src1_sel:WORD_1
    s_cbranch_vccnz K2_RT0
    v_mad_u32_u16 v28, v12, 12, v5
    v_max_u32 v9, v9, v12
    s_mov_b64 exec, s[56:57]
    s_cbranch_execz K2_NS0
    buffer_load_dwordx3 v[44:46], v28, s[16:19], s46 offen offset:192 sc1
K2_NS0:
    s_mov_b64 exec, s[54:55]
    buffer_load_dwordx3 v[40:42], v28, s[16:19], s46 offen sc1
    s_mov_b64 exec, -1
    s_add_u32 s46, s46, 1228800
K2_CK1:
    v_cmp_ne_u32 vcc, s91, v15
    v_cmp_lt_u32_sdwa s[58:59], v6, v14 src0_sel:DWORD src1_sel:WORD_1
    v_cmp_lt_u32_sdwa s[60:61], v1, v14 src0_sel:DWORD src1_sel:WORD_1
    s_cbranch_vccnz K2_RT1
    v_mad_u32_u16 v29, v14, 12, v5
    v_max_u32 v9, v9, v14
    s_mov_b64 exec, s[60:61]
    s_cbranch_execz K2_NS1
    buffer_load_dwordx3 v[52:54], v29, s[16:19], s46 offen offset:192 sc1
K2_NS1:
    s_mov_b64 exec, s[58:59]
    buffer_load_dwordx3 v[48:50], v29, s[16:19], s46 offen sc1
    s_mov_b64 exec, -1
    s_add_u32 s46, s46, 1228800
K2_CK2:
    v_cmp_ne_u32 vcc, s91, v17
    v_cmp_lt_u32_sdwa s[62:63], v6, v16 src0_sel:DWORD src1_sel:WORD_1
    v_cmp_lt_u32_sdwa s[64:65], v1, v16 src0_sel:DWORD src1_sel:WORD_1
    s_cbranch_vccnz K2_RT2
    v_mad_u32_u16 v30, v16, 12, v5
    v_max_u32 v9, v9, v16
    s_mov_b64 exec, s[64:65]
    s_cbranch_execz K2_NS2
    buffer_load_dwordx3 v[60:62], v30, s[16:19], s46 offen offset:192 sc1
K2_NS2:
    s_mov_b64 exec, s[62:63]
    buffer_load_dwordx3 v[56:58], v30, s[16:19], s46 offen sc1
    s_mov_b64 exec, -1
    s_add_u32 s46, s46, 1228800
K2_CK3:
    v_cmp_ne_u32 vcc, s91, v19
    v_cmp_lt_u32_sdwa s[66:67], v6, v18 src0_sel:DWORD src1_sel:WORD_1
    v_cmp_lt_u32_sdwa s[68:69], v1, v18 src0_sel:DWORD src1_sel:WORD_1
    s_cbranch_vccnz K2_RT3
    v_mad_u32_u16 v31, v18, 12, v5
    v_max_u32 v9, v9, v18
    s_mov_b64 exec, s[68:69]
    s_cbranch_execz K2_NS3
    buffer_load_dwordx3 v[68:70], v31, s[16:19], s46 offen offset:192 sc1
K2_NS3:
    s_mov_b64 exec, s[66:67]
    buffer_load_dwordx3 v[64:66], v31, s[16:19], s46 offen sc1
    s_mov_b64 exec, -1
    s_add_u32 s46, s46, 1228800
K2_CK4:
    v_cmp_ne_u32 vcc, s91, v21
    v_cmp_lt_u32_sdwa s[70:71], v6, v20 src0_sel:DWORD src1_sel:WORD_1
    v_cmp_lt_u32_sdwa s[72:73], v1, v20 src0_sel:DWORD src1_sel:WORD_1
    s_cbranch_vccnz K2_RT4
    v_mad_u32_u16 v32, v20, 12, v5
    v_max_u32 v9, v9, v20
    s_mov_b64 exec, s[72:73]
    s_cbranch_execz K2_NS4
    buffer_load_dwordx3 v[76:78], v32, s[16:19], s46 offen offset:192 sc1
K2_NS4:
    s_mov_b64 exec, s[70:71]
    buffer_load_dwordx3 v[72:74], v32, s[16:19], s46 offen sc1
    s_mov_b64 exec, -1
    s_add_u32 s46, s46, 1228800
K2_CK5:
    v_cmp_ne_u32 vcc, s91, v23
    v_cmp_lt_u32_sdwa s[74:75], v6, v22 src0_sel:DWORD src1_sel:WORD_1
    v_cmp_lt_u32_sdwa s[76:77], v1, v22 src0_sel:DWORD src1_sel:WORD_1
    s_cbranch_vccnz K2_RT5
    v_mad_u32_u16 v33, v22, 12, v5
    v_max_u32 v9, v9, v22
    s_mov_b64 exec, s[76:77]
    s_cbranch_execz K2_NS5
    buffer_load_dwordx3 v[84:86], v33, s[16:19], s46 offen offset:192 sc1
K2_NS5:
    s_mov_b64 exec, s[74:75]
    buffer_load_dwordx3 v[80:82], v33, s[16:19], s46 offen sc1
    s_mov_b64 exec, -1
    s_add_u32 s46, s46, 1228800
K2_CK6:
    v_cmp_ne_u32 vcc, s91, v25
    v_cmp_lt_u32_sdwa s[78:79], v6, v24 src0_sel:DWORD src1_sel:WORD_1
    v_cmp_lt_u32_sdwa s[80:81], v1, v24 src0_sel:DWORD src1_sel:WORD_1
    s_cbranch_vccnz K2_RT6
    v_mad_u32_u16 v34, v24, 12, v5
    v_max_u32 v9, v9, v24
    s_mov_b64 exec, s[80:81]
    s_cbranch_execz K2_NS6
    buffer_load_dwordx3 v[92:94], v34, s[16:19], s46 offen offset:192 sc1
K2_NS6:
    s_mov_b64 exec, s[78:79]
    buffer_load_dwordx3 v[88:90], v34, s[16:19], s46 offen sc1
    s_mov_b64 exec, -1
    s_add_u32 s46, s46, 1228800
K2_CK7:
    v_cmp_ne_u32 vcc, s91, v27
    v_cmp_lt_u32_sdwa s[82:83], v6, v26 src0_sel:DWORD src1_sel:WORD_1
    v_cmp_lt_u32_sdwa s[84:85], v1, v26 src0_sel:DWORD src1_sel:WORD_1
    s_cbranch_vccnz K2_RT7
    v_mad_u32_u16 v35, v26, 12, v5
    v_max_u32 v9, v9, v26
    s_mov_b64 exec, s[84:85]
    s_cbranch_execz K2_NS7
    buffer_load_dwordx3 v[100:102], v35, s[16:19], s46 offen offset:192 sc1
K2_NS7:
    s_mov_b64 exec, s[82:83]
    buffer_load_dwordx3 v[96:98], v35, s[16:19], s46 offen sc1
    s_mov_b64 exec, -1
    s_add_u32 s46, s46, 1228800
    s_branch K2_ALLIN
K2_RT0:
    s_cmp_lg_u32 s47, 0
    s_cbranch_scc1 K2_RL0
    v_cndmask_b32_e64 v12, v12, 0, vcc
    v_mov_b32 v13, s91
    s_branch K2_CK0
K2_RL0:
    s_sub_u32 s47, s47, 1
    s_add_u32 s44, s45, 0
    buffer_load_dwordx2 v[12:13], v3, s[16:19], s44 offen sc1
    s_add_u32 s44, s44, 65536
    buffer_load_dwordx2 v[14:15], v3, s[16:19], s44 offen sc1
    s_add_u32 s44, s44, 65536
    buffer_load_dwordx2 v[16:17], v3, s[16:19], s44 offen sc1
    s_add_u32 s44, s44, 65536
    buffer_load_dwordx2 v[18:19], v3, s[16:19], s44 offen sc1
    s_add_u32 s44, s44, 65536
    buffer_load_dwordx2 v[20:21], v3, s[16:19], s44 offen sc1
    s_add_u32 s44, s44, 65536
    buffer_load_dwordx2 v[22:23], v3, s[16:19], s44 offen sc1
    s_add_u32 s44, s44, 65536
    buffer_load_dwordx2 v[24:25], v3, s[16:19], s44 offen sc1
    s_add_u32 s44, s44, 65536
    buffer_load_dwordx2 v[26:27], v3, s[16:19], s44 offen sc1
    s_waitcnt vmcnt(0)
    s_branch K2_CK0
K2_RT1:
    s_cmp_lg_u32 s47, 0
    s_cbranch_scc1 K2_RL1
    v_cndmask_b32_e64 v14, v14, 0, vcc
    v_mov_b32 v15, s91
    s_branch K2_CK1
K2_RL1:
    s_sub_u32 s47, s47, 1
    s_add_u32 s44, s45, 65536
    buffer_load_dwordx2 v[14:15], v3, s[16:19], s44 offen sc1
    s_add_u32 s44, s44, 65536
    buffer_load_dwordx2 v[16:17], v3, s[16:19], s44 offen sc1
    s_add_u32 s44, s44, 65536
    buffer_load_dwordx2 v[18:19], v3, s[16:19], s44 offen sc1
    s_add_u32 s44, s44, 65536
    buffer_load_dwordx2 v[20:21], v3, s[16:19], s44 offen sc1
    s_add_u32 s44, s44, 65536
    buffer_load_dwordx2 v[22:23], v3, s[16:19], s44 offen sc1
    s_add_u32 s44, s44, 65536
    buffer_load_dwordx2 v[24:25], v3, s[16:19], s44 offen sc1
    s_add_u32 s44, s44, 65536
    buffer_load_dwordx2 v[26:27], v3, s[16:19], s44 offen sc1
    s_waitcnt vmcnt(0)
    s_branch K2_CK1
K2_RT2:
    s_cmp_lg_u32 s47, 0
    s_cbranch_scc1 K2_RL2
    v_cndmask_b32_e64 v16, v16, 0, vcc
    v_mov_b32 v17, s91
    s_branch K2_CK2
K2_RL2:
    s_sub_u32 s47, s47, 1
    s_add_u32 s44, s45, 131072
    buffer_load_dwordx2 v[16:17], v3, s[16:19], s44 offen sc1
    s_add_u32 s44, s44, 65536
    buffer_load_dwordx2 v[18:19], v3, s[16:19], s44 offen sc1
    s_add_u32 s44, s44, 65536
    buffer_load_dwordx2 v[20:21], v3, s[16:19], s44 offen sc1
    s_add_u32 s44, s44, 65536
    buffer_load_dwordx2 v[22:23], v3, s[16:19], s44 offen sc1
    s_add_u32 s44, s44, 65536
    buffer_load_dwordx2 v[24:25], v3, s[16:19], s44 offen sc1
    s_add_u32 s44, s44, 65536
    buffer_load_dwordx2 v[26:27], v3, s[16:19], s44 offen sc1
    s_waitcnt vmcnt(0)
    s_branch K2_CK2
K2_RT3:
    s_cmp_lg_u32 s47, 0
    s_cbranch_scc1 K2_RL3
    v_cndmask_b32_e64 v18, v18, 0, vcc
    v_mov_b32 v19, s91
    s_branch K2_CK3
K2_RL3:
    s_sub_u32 s47, s47, 1
    s_add_u32 s44, s45, 196608
    buffer_load_dwordx2 v[18:19], v3, s[16:19], s44 offen sc1
    s_add_u32 s44, s44, 65536
    buffer_load_dwordx2 v[20:21], v3, s[16:19], s44 offen sc1
    s_add_u32 s44, s44, 65536
    buffer_load_dwordx2 v[22:23], v3, s[16:19], s44 offen sc1
    s_add_u32 s44, s44, 65536
    buffer_load_dwordx2 v[24:25], v3, s[16:19], s44 offen sc1
    s_add_u32 s44, s44, 65536
    buffer_load_dwordx2 v[26:27], v3, s[16:19], s44 offen sc1
    s_waitcnt vmcnt(0)
    s_branch K2_CK3
K2_RT4:
    s_cmp_lg_u32 s47, 0
    s_cbranch_scc1 K2_RL4
    v_cndmask_b32_e64 v20, v20, 0, vcc
    v_mov_b32 v21, s91
    s_branch K2_CK4
K2_RL4:
    s_sub_u32 s47, s47, 1
    s_add_u32 s44, s45, 262144
    buffer_load_dwordx2 v[20:21], v3, s[16:19], s44 offen sc1
    s_add_u32 s44, s44, 65536
    buffer_load_dwordx2 v[22:23], v3, s[16:19], s44 offen sc1
    s_add_u32 s44, s44, 65536
    buffer_load_dwordx2 v[24:25], v3, s[16:19], s44 offen sc1
    s_add_u32 s44, s44, 65536
    buffer_load_dwordx2 v[26:27], v3, s[16:19], s44 offen sc1
    s_waitcnt vmcnt(0)
    s_branch K2_CK4
K2_RT5:
    s_cmp_lg_u32 s47, 0
    s_cbranch_scc1 K2_RL5
    v_cndmask_b32_e64 v22, v22, 0, vcc
    v_mov_b32 v23, s91
    s_branch K2_CK5
K2_RL5:
    s_sub_u32 s47, s47, 1
    s_add_u32 s44, s45, 327680
    buffer_load_dwordx2 v[22:23], v3, s[16:19], s44 offen sc1
    s_add_u32 s44, s44, 65536
    buffer_load_dwordx2 v[24:25], v3, s[16:19], s44 offen sc1
    s_add_u32 s44, s44, 65536
    buffer_load_dwordx2 v[26:27], v3, s[16:19], s44 offen sc1
    s_waitcnt vmcnt(0)
    s_branch K2_CK5
K2_RT6:
    s_cmp_lg_u32 s47, 0
    s_cbranch_scc1 K2_RL6
    v_cndmask_b32_e64 v24, v24, 0, vcc
    v_mov_b32 v25, s91
    s_branch K2_CK6
K2_RL6:
    s_sub_u32 s47, s47, 1
    s_add_u32 s44, s45, 393216
    buffer_load_dwordx2 v[24:25], v3, s[16:19], s44 offen sc1
    s_add_u32 s44, s44, 65536
    buffer_load_dwordx2 v[26:27], v3, s[16:19], s44 offen sc1
    s_waitcnt vmcnt(0)
    s_branch K2_CK6
K2_RT7:
    s_cmp_lg_u32 s47, 0
    s_cbranch_scc1 K2_RL7
    v_cndmask_b32_e64 v26, v26, 0, vcc
    v_mov_b32 v27, s91
    s_branch K2_CK7
K2_RL7:
    s_sub_u32 s47, s47, 1
    s_add_u32 s44, s45, 458752
    buffer_load_dwordx2 v[26:27], v3, s[16:19], s44 offen sc1
    s_waitcnt vmcnt(0)
    s_branch K2_CK7
K2_ALLIN:
    s_waitcnt lgkmcnt(0)
    s_barrier
    s_mul_i32 s44, s3, 2560
    s_add_u32 m0, s44, 70752
    v_lshlrev_b32 v7, 4, v175
    s_add_u32 s45, s44, 26377216
    buffer_load_dwordx4 v7, s[16:19], s45 offen offset:0 sc1 lds
    buffer_load_dwordx4 v7, s[16:19], s45 offen offset:1024 sc1 lds
    v_cmp_gt_u32 vcc, 32, v175
    s_mov_b64 exec, vcc
    buffer_load_dwordx4 v7, s[16:19], s45 offen offset:2048 sc1 lds
    s_mov_b64 exec, -1
    s_mov_b32 s45, 335
    s_mov_b64 exec, s[54:55]
    s_waitcnt vmcnt(10)
    v_mul_u32_u24_sdwa v3, s45, v41 dst_sel:DWORD dst_unused:UNUSED_PAD src0_sel:DWORD src1_sel:WORD_1
    v_lshrrev_b32 v43, 26, v42
    v_lshrrev_b32 v3, 20, v3
    v_lshl_add_u32 v3, v43, 2, v3
    v_lshl_add_u32 v120, v3, 2, s90
    ds_add_rtn_u32 v104, v120, v2
    v_mul_u32_u24 v43, 1424, v43
    s_mov_b64 exec, s[56:57]
    s_cbranch_execz K2_GA1
    v_mul_u32_u24_sdwa v3, s45, v45 dst_sel:DWORD dst_unused:UNUSED_PAD src0_sel:DWORD src1_sel:WORD_1
    v_lshrrev_b32 v47, 26, v46
    v_lshrrev_b32 v3, 20, v3
    v_lshl_add_u32 v3, v47, 2, v3
    v_lshl_add_u32 v121, v3, 2, s90
    ds_add_rtn_u32 v105, v121, v2
    v_mul_u32_u24 v47, 1424, v47
K2_GA1:
    s_mov_b64 exec, s[58:59]
    s_waitcnt vmcnt(9)
    v_mul_u32_u24_sdwa v3, s45, v49 dst_sel:DWORD dst_unused:UNUSED_PAD src0_sel:DWORD src1_sel:WORD_1
    v_lshrrev_b32 v51, 26, v50
    v_lshrrev_b32 v3, 20, v3
    v_lshl_add_u32 v3, v51, 2, v3
    v_lshl_add_u32 v122, v3, 2, s90
    ds_add_rtn_u32 v106, v122, v2
    v_mul_u32_u24 v51, 1424, v51
    s_mov_b64 exec, s[60:61]
    s_cbranch_execz K2_GA3
    v_mul_u32_u24_sdwa v3, s45, v53 dst_sel:DWORD dst_unused:UNUSED_PAD src0_sel:DWORD src1_sel:WORD_1
    v_lshrrev_b32 v55, 26, v54
    v_lshrrev_b32 v3, 20, v3
    v_lshl_add_u32 v3, v55, 2, v3
    v_lshl_add_u32 v123, v3, 2, s90
    ds_add_rtn_u32 v107, v123, v2
    v_mul_u32_u24 v55, 1424, v55
K2_GA3:
    s_mov_b64 exec, s[62:63]
    s_waitcnt vmcnt(8)
    v_mul_u32_u24_sdwa v3, s45, v57 dst_sel:DWORD dst_unused:UNUSED_PAD src0_sel:DWORD src1_sel:WORD_1
    v_lshrrev_b32 v59, 26, v58
    v_lshrrev_b32 v3, 20, v3
    v_lshl_add_u32 v3, v59, 2, v3
    v_lshl_add_u32 v124, v3, 2, s90
    ds_add_rtn_u32 v108, v124, v2
    v_mul_u32_u24 v59, 1424, v59
    s_mov_b64 exec, s[64:65]
    s_cbranch_execz K2_GA5
    v_mul_u32_u24_sdwa v3, s45, v61 dst_sel:DWORD dst_unused:UNUSED_PAD src0_sel:DWORD src1_sel:WORD_1
    v_lshrrev_b32 v63, 26, v62
    v_lshrrev_b32 v3, 20, v3
    v_lshl_add_u32 v3, v63, 2, v3
    v_lshl_add_u32 v125, v3, 2, s90
    ds_add_rtn_u32 v109, v125, v2
    v_mul_u32_u24 v63, 1424, v63
K2_GA5:
    s_mov_b64 exec, s[66:67]
    s_waitcnt vmcnt(7)
    v_mul_u32_u24_sdwa v3, s45, v65 dst_sel:DWORD dst_unused:UNUSED_PAD src0_sel:DWORD src1_sel:WORD_1
    v_lshrrev_b32 v67, 26, v66
    v_lshrrev_b32 v3, 20, v3
    v_lshl_add_u32 v3, v67, 2, v3
    v_lshl_add_u32 v126, v3, 2, s90
    ds_add_rtn_u32 v110, v126, v2
    v_mul_u32_u24 v67, 1424, v67
    s_mov_b64 exec, s[68:69]
    s_cbranch_execz K2_GA7
    v_mul_u32_u24_sdwa v3, s45, v69 dst_sel:DWORD dst_unused:UNUSED_PAD src0_sel:DWORD src1_sel:WORD_1
    v_lshrrev_b32 v71, 26, v70
    v_lshrrev_b32 v3, 20, v3
    v_lshl_add_u32 v3, v71, 2, v3
    v_lshl_add_u32 v127, v3, 2, s90
    ds_add_rtn_u32 v111, v127, v2
    v_mul_u32_u24 v71, 1424, v71
K2_GA7:
    s_mov_b64 exec, s[70:71]
    s_waitcnt vmcnt(6)
    v_mul_u32_u24_sdwa v3, s45, v73 dst_sel:DWORD dst_unused:UNUSED_PAD src0_sel:DWORD src1_sel:WORD_1
    v_lshrrev_b32 v75, 26, v74
    v_lshrrev_b32 v3, 20, v3
    v_lshl_add_u32 v3, v75, 2, v3
    v_lshl_add_u32 v128, v3, 2, s90
    ds_add_rtn_u32 v112, v128, v2
    v_mul_u32_u24 v75, 1424, v75
    s_mov_b64 exec, s[72:73]
    s_cbranch_execz K2_GA9
    v_mul_u32_u24_sdwa v3, s45, v77 dst_sel:DWORD dst_unused:UNUSED_PAD src0_sel:DWORD src1_sel:WORD_1
    v_lshrrev_b32 v79, 26, v78
    v_lshrrev_b32 v3, 20, v3
    v_lshl_add_u32 v3, v79, 2, v3
    v_lshl_add_u32 v129, v3, 2, s90
    ds_add_rtn_u32 v113, v129, v2
    v_mul_u32_u24 v79, 1424, v79
K2_GA9:
    s_mov_b64 exec, s[74:75]
    s_waitcnt vmcnt(5)
    v_mul_u32_u24_sdwa v3, s45, v81 dst_sel:DWORD dst_unused:UNUSED_PAD src0_sel:DWORD src1_sel:WORD_1
    v_lshrrev_b32 v83, 26, v82
    v_lshrrev_b32 v3, 20, v3
    v_lshl_add_u32 v3, v83, 2, v3
    v_lshl_add_u32 v130, v3, 2, s90
    ds_add_rtn_u32 v114, v130, v2
    v_mul_u32_u24 v83, 1424, v83
    s_mov_b64 exec, s[76:77]
    s_cbranch_execz K2_GA11
    v_mul_u32_u24_sdwa v3, s45, v85 dst_sel:DWORD dst_unused:UNUSED_PAD src0_sel:DWORD src1_sel:WORD_1
    v_lshrrev_b32 v87, 26, v86
    v_lshrrev_b32 v3, 20, v3
    v_lshl_add_u32 v3, v87, 2, v3
    v_lshl_add_u32 v131, v3, 2, s90
    ds_add_rtn_u32 v115, v131, v2
    v_mul_u32_u24 v87, 1424, v87
K2_GA11:
    s_mov_b64 exec, s[78:79]
    s_waitcnt vmcnt(4)
    v_mul_u32_u24_sdwa v3, s45, v89 dst_sel:DWORD dst_unused:UNUSED_PAD src0_sel:DWORD src1_sel:WORD_1
    v_lshrrev_b32 v91, 26, v90
    v_lshrrev_b32 v3, 20, v3
    v_lshl_add_u32 v3, v91, 2, v3
    v_lshl_add_u32 v132, v3, 2, s90
    ds_add_rtn_u32 v116, v132, v2
    v_mul_u32_u24 v91, 1424, v91
    s_mov_b64 exec, s[80:81]
    s_cbranch_execz K2_GA13
    v_mul_u32_u24_sdwa v3, s45, v93 dst_sel:DWORD dst_unused:UNUSED_PAD src0_sel:DWORD src1_sel:WORD_1
    v_lshrrev_b32 v95, 26, v94
    v_lshrrev_b32 v3, 20, v3
    v_lshl_add_u32 v3, v95, 2, v3
    v_lshl_add_u32 v133, v3, 2, s90
    ds_add_rtn_u32 v117, v133, v2
    v_mul_u32_u24 v95, 1424, v95
K2_GA13:
    s_mov_b64 exec, s[82:83]
    s_waitcnt vmcnt(3)
    v_mul_u32_u24_sdwa v3, s45, v97 dst_sel:DWORD dst_unused:UNUSED_PAD src0_sel:DWORD src1_sel:WORD_1
    v_lshrrev_b32 v99, 26, v98
    v_lshrrev_b32 v3, 20, v3
    v_lshl_add_u32 v3, v99, 2, v3
    v_lshl_add_u32 v134, v3, 2, s90
    ds_add_rtn_u32 v118, v134, v2
    v_mul_u32_u24 v99, 1424, v99
    s_mov_b64 exec, s[84:85]
    s_cbranch_execz K2_GA15
    v_mul_u32_u24_sdwa v3, s45, v101 dst_sel:DWORD dst_unused:UNUSED_PAD src0_sel:DWORD src1_sel:WORD_1
    v_lshrrev_b32 v103, 26, v102
    v_lshrrev_b32 v3, 20, v3
    v_lshl_add_u32 v3, v103, 2, v3
    v_lshl_add_u32 v135, v3, 2, s90
    ds_add_rtn_u32 v119, v135, v2
    v_mul_u32_u24 v103, 1424, v103
K2_GA15:
    s_mov_b64 exec, -1
    v_lshrrev_b32 v9, 16, v9
    s_mov_b64 exec, -1
    s_lshr_b32 s44, s2, 3
    s_lshl_b32 s44, s44, 3
    s_add_u32 s44, s44, s3
    s_lshl_b32 s44, s44, 13
    s_add_u32 s44, s44, 3072
    v_lshlrev_b32 v160, 7, v175
    buffer_load_dword v161, v160, s[8:11], s44 offen
    s_add_u32 s44, s44, 2097152
    v_add_u32 v8, 16, v1
    s_mov_b32 s45, 32
K2_XLA:
    v_cmp_lt_u32 vcc, s45, v9
    s_cbranch_vccz K2_XDA
    s_mul_i32 s44, s45, 12
    s_add_u32 s44, s44, 16777216
    v_cmp_lt_u32_sdwa vcc, v8, v12 src0_sel:DWORD src1_sel:WORD_1
    s_and_saveexec_b64 s[46:47], vcc
    s_cbranch_execz K2_XSA0
    buffer_load_dwordx3 v[136:138], v28, s[16:19], s44 offen sc1
    s_waitcnt vmcnt(0)
    v_lshrrev_b32 v139, 26, v138
    v_lshl_add_u32 v3, v139, 2, s90
    ds_add_u32 v3, v2 offset:1024
K2_XSA0:
    s_mov_b64 exec, -1
    s_add_u32 s44, s44, 1228800
    v_cmp_lt_u32_sdwa vcc, v8, v14 src0_sel:DWORD src1_sel:WORD_1
    s_and_saveexec_b64 s[46:47], vcc
    s_cbranch_execz K2_XSA1
    buffer_load_dwordx3 v[136:138], v29, s[16:19], s44 offen sc1
    s_waitcnt vmcnt(0)
    v_lshrrev_b32 v139, 26, v138
    v_lshl_add_u32 v3, v139, 2, s90
    ds_add_u32 v3, v2 offset:1024
K2_XSA1:
    s_mov_b64 exec, -1
    s_add_u32 s44, s44, 1228800
    v_cmp_lt_u32_sdwa vcc, v8, v16 src0_sel:DWORD src1_sel:WORD_1
    s_and_saveexec_b64 s[46:47], vcc
    s_cbranch_execz K2_XSA2
    buffer_load_dwordx3 v[136:138], v30, s[16:19], s44 offen sc1
    s_waitcnt vmcnt(0)
    v_lshrrev_b32 v139, 26, v138
    v_lshl_add_u32 v3, v139, 2, s90
    ds_add_u32 v3, v2 offset:1024
K2_XSA2:
    s_mov_b64 exec, -1
    s_add_u32 s44, s44, 1228800
    v_cmp_lt_u32_sdwa vcc, v8, v18 src0_sel:DWORD src1_sel:WORD_1
    s_and_saveexec_b64 s[46:47], vcc
    s_cbranch_execz K2_XSA3
    buffer_load_dwordx3 v[136:138], v31, s[16:19], s44 offen sc1
    s_waitcnt vmcnt(0)
    v_lshrrev_b32 v139, 26, v138
    v_lshl_add_u32 v3, v139, 2, s90
    ds_add_u32 v3, v2 offset:1024
K2_XSA3:
    s_mov_b64 exec, -1
    s_add_u32 s44, s44, 1228800
    v_cmp_lt_u32_sdwa vcc, v8, v20 src0_sel:DWORD src1_sel:WORD_1
    s_and_saveexec_b64 s[46:47], vcc
    s_cbranch_execz K2_XSA4
    buffer_load_dwordx3 v[136:138], v32, s[16:19], s44 offen sc1
    s_waitcnt vmcnt(0)
    v_lshrrev_b32 v139, 26, v138
    v_lshl_add_u32 v3, v139, 2, s90
    ds_add_u32 v3, v2 offset:1024
K2_XSA4:
    s_mov_b64 exec, -1
    s_add_u32 s44, s44, 1228800
    v_cmp_lt_u32_sdwa vcc, v8, v22 src0_sel:DWORD src1_sel:WORD_1
    s_and_saveexec_b64 s[46:47], vcc
    s_cbranch_execz K2_XSA5
    buffer_load_dwordx3 v[136:138], v33, s[16:19], s44 offen sc1
    s_waitcnt vmcnt(0)
    v_lshrrev_b32 v139, 26, v138
    v_lshl_add_u32 v3, v139, 2, s90
    ds_add_u32 v3, v2 offset:1024
K2_XSA5:
    s_mov_b64 exec, -1
    s_add_u32 s44, s44, 1228800
    v_cmp_lt_u32_sdwa vcc, v8, v24 src0_sel:DWORD src1_sel:WORD_1
    s_and_saveexec_b64 s[46:47], vcc
    s_cbranch_execz K2_XSA6
    buffer_load_dwordx3 v[136:138], v34, s[16:19], s44 offen sc1
    s_waitcnt vmcnt(0)
    v_lshrrev_b32 v139, 26, v138
    v_lshl_add_u32 v3, v139, 2, s90
    ds_add_u32 v3, v2 offset:1024
K2_XSA6:
    s_mov_b64 exec, -1
    s_add_u32 s44, s44, 1228800
    v_cmp_lt_u32_sdwa vcc, v8, v26 src0_sel:DWORD src1_sel:WORD_1
    s_and_saveexec_b64 s[46:47], vcc
    s_cbranch_execz K2_XSA7
    buffer_load_dwordx3 v[136:138], v35, s[16:19], s44 offen sc1
    s_waitcnt vmcnt(0)
    v_lshrrev_b32 v139, 26, v138
    v_lshl_add_u32 v3, v139, 2, s90
    ds_add_u32 v3, v2 offset:1024
K2_XSA7:
    s_mov_b64 exec, -1
    s_add_u32 s44, s44, 1228800
    s_add_u32 s45, s45, 16
    v_add_u32 v8, 16, v8
    s_branch K2_XLA
K2_XDA:
    v_lshl_add_u32 v3, v175, 4, s90
    v_lshl_add_u32 v10, v175, 2, s90
    v_cmp_gt_u32 s[46:47], s25, v175
    v_mul_u32_u24 v5, 712, v175
    s_waitcnt lgkmcnt(0)
    s_barrier
    ds_read_b128 v[140:143], v3 offset:0
    ds_read_b32 v4, v10 offset:1024
    v_add_u32 v5, 8, v5
    v_mov_b32 v144, 0
    s_waitcnt lgkmcnt(0)
    v_mov_b32 v145, v140
    v_add_u32 v146, v145, v141
    v_add_u32 v147, v146, v142
    v_add_u32 v11, v147, v143
    v_add_u32 v4, v4, v11
    v_cmp_lt_u32 vcc, 112, v4
    s_cbranch_vccz K2_FITS
    s_waitcnt vmcnt(0)
    s_barrier
    s_cmp_gt_u32 s27, 1
    s_cselect_b32 s29, 0, 1
    s_add_u32 s27, s27, 1
    s_lshr_b32 s27, s27, 1
    s_branch K2_WIN
K2_FITS:
    v_add_u32 v6, 15, v4
    v_lshrrev_b32 v6, 4, v6
    v_max_u32 v6, 1, v6
    v_med3_u32 v7, v6, 3, 6
    v_mov_b32 v8, v175
    v_cndmask_b32_e64 v1, 0, v7, s[46:47]
    s_mov_b32 s45, 0
    v_cmp_eq_u32 vcc, 6, v1
    v_mov_b32 v7, s45
    s_bcnt1_i32_b64 s44, vcc
    v_mbcnt_lo_u32_b32 v7, vcc_lo, v7
    v_mbcnt_hi_u32_b32 v7, vcc_hi, v7
    s_add_u32 s45, s45, s44
    v_cndmask_b32 v8, v8, v7, vcc
    v_cmp_eq_u32 vcc, 5, v1
    v_mov_b32 v7, s45
    s_bcnt1_i32_b64 s44, vcc
    v_mbcnt_lo_u32_b32 v7, vcc_lo, v7
    v_mbcnt_hi_u32_b32 v7, vcc_hi, v7
    s_add_u32 s45, s45, s44
    v_cndmask_b32 v8, v8, v7, vcc
    v_cmp_eq_u32 vcc, 4, v1
    v_mov_b32 v7, s45
    s_bcnt1_i32_b64 s44, vcc
    v_mbcnt_lo_u32_b32 v7, vcc_lo, v7
    v_mbcnt_hi_u32_b32 v7, vcc_hi, v7
    s_add_u32 s45, s45, s44
    v_cndmask_b32 v8, v8, v7, vcc
    v_cmp_eq_u32 vcc, 3, v1
    v_mov_b32 v7, s45
    s_bcnt1_i32_b64 s44, vcc
    v_mbcnt_lo_u32_b32 v7, vcc_lo, v7
    v_mbcnt_hi_u32_b32 v7, vcc_hi, v7
    s_add_u32 s45, s45, s44
    v_cndmask_b32 v8, v8, v7, vcc
    v_and_b32 v7, 16, v8
    v_cmp_ne_u32 vcc, 0, v7
    v_sub_u32 v140, v11, v140
    v_sub_u32 v141, v11, v141
    v_sub_u32 v142, v11, v142
    v_sub_u32 v143, v11, v143
    v_sub_u32 v140, v140, v144
    v_sub_u32 v141, v141, v145
    v_sub_u32 v142, v142, v146
    v_sub_u32 v143, v143, v147
    v_cndmask_b32 v144, v144, v140, vcc
    v_cndmask_b32 v145, v145, v141, vcc
    v_cndmask_b32 v146, v146, v142, vcc
    v_cndmask_b32 v147, v147, v143, vcc
    ds_write_b128 v3, v[144:147] offset:4096
    ds_write_b32 v10, v11 offset:5120
    s_mov_b64 exec, s[54:55]
    ds_read_b32 v120, v120 offset:4096
    s_mov_b64 exec, s[56:57]
    s_cbranch_execz K2_GB1
    ds_read_b32 v121, v121 offset:4096
K2_GB1:
    s_mov_b64 exec, s[58:59]
    ds_read_b32 v122, v122 offset:4096
    s_mov_b64 exec, s[60:61]
    s_cbranch_execz K2_GB3
    ds_read_b32 v123, v123 offset:4096
K2_GB3:
    s_mov_b64 exec, s[62:63]
    ds_read_b32 v124, v124 offset:4096
    s_mov_b64 exec, s[64:65]
    s_cbranch_execz K2_GB5
    ds_read_b32 v125, v125 offset:4096
K2_GB5:
    s_mov_b64 exec, s[66:67]
    ds_read_b32 v126, v126 offset:4096
    s_mov_b64 exec, s[68:69]
    s_cbranch_execz K2_GB7
    ds_read_b32 v127, v127 offset:4096
K2_GB7:
    s_mov_b64 exec, s[70:71]
    ds_read_b32 v128, v128 offset:4096
    s_mov_b64 exec, s[72:73]
    s_cbranch_execz K2_GB9
    ds_read_b32 v129, v129 offset:4096
K2_GB9:
    s_mov_b64 exec, s[74:75]
    ds_read_b32 v130, v130 offset:4096
    s_mov_b64 exec, s[76:77]
    s_cbranch_execz K2_GB11
    ds_read_b32 v131, v131 offset:4096
K2_GB11:
    s_mov_b64 exec, s[78:79]
    ds_read_b32 v132, v132 offset:4096
    s_mov_b64 exec, s[80:81]
    s_cbranch_execz K2_GB13
    ds_read_b32 v133, v133 offset:4096
K2_GB13:
    s_mov_b64 exec, s[82:83]
    ds_read_b32 v134, v134 offset:4096
    s_mov_b64 exec, s[84:85]
    s_cbranch_execz K2_GB15
    ds_read_b32 v135, v135 offset:4096
K2_GB15:
    s_mov_b64 exec, -1
    v_lshlrev_b32 v7, 4, v6
    v_sub_u32 v7, v4, v7
    v_add_u32 v7, 19, v7
    v_lshrrev_b32 v7, 2, v7
    v_or_b32 v5, v5, v6
    v_lshl_or_b32 v5, v7, 16, v5
    v_subrev_u32 v7, 1, v6
    v_lshl_or_b32 v5, v7, 20, v5
    v_mov_b32 v7, 34896
    v_cndmask_b32_e64 v247, v7, v5, s[46:47]
    v_lshlrev_b32 v7, 2, v8
    v_and_b32 v6, 15, v175
    s_waitcnt lgkmcnt(0)
    ds_permute_b32 v247, v7, v247
    v_add_u32 v1, 16, v6
    s_mov_b64 exec, s[54:55]
    v_add_u32 v104, v104, v120
    v_lshl_add_u32 v43, v104, 2, v43
    ds_write2_b32 v43, v40, v41 offset0:4 offset1:116
    ds_write_b32 v43, v42 offset:912
    s_mov_b64 exec, s[56:57]
    s_cbranch_execz K2_GC1
    v_add_u32 v105, v105, v121
    v_lshl_add_u32 v47, v105, 2, v47
    ds_write2_b32 v47, v44, v45 offset0:4 offset1:116
    ds_write_b32 v47, v46 offset:912
K2_GC1:
    s_mov_b64 exec, s[58:59]
    v_add_u32 v106, v106, v122
    v_lshl_add_u32 v51, v106, 2, v51
    ds_write2_b32 v51, v48, v49 offset0:4 offset1:116
    ds_write_b32 v51, v50 offset:912
    s_mov_b64 exec, s[60:61]
    s_cbranch_execz K2_GC3
    v_add_u32 v107, v107, v123
    v_lshl_add_u32 v55, v107, 2, v55
    ds_write2_b32 v55, v52, v53 offset0:4 offset1:116
    ds_write_b32 v55, v54 offset:912
K2_GC3:
    s_mov_b64 exec, s[62:63]
    v_add_u32 v108, v108, v124
    v_lshl_add_u32 v59, v108, 2, v59
    ds_write2_b32 v59, v56, v57 offset0:4 offset1:116
    ds_write_b32 v59, v58 offset:912
    s_mov_b64 exec, s[64:65]
    s_cbranch_execz K2_GC5
    v_add_u32 v109, v109, v125
    v_lshl_add_u32 v63, v109, 2, v63
    ds_write2_b32 v63, v60, v61 offset0:4 offset1:116
    ds_write_b32 v63, v62 offset:912
K2_GC5:
    s_mov_b64 exec, s[66:67]
    v_add_u32 v110, v110, v126
    v_lshl_add_u32 v67, v110, 2, v67
    ds_write2_b32 v67, v64, v65 offset0:4 offset1:116
    ds_write_b32 v67, v66 offset:912
    s_mov_b64 exec, s[68:69]
    s_cbranch_execz K2_GC7
    v_add_u32 v111, v111, v127
    v_lshl_add_u32 v71, v111, 2, v71
    ds_write2_b32 v71, v68, v69 offset0:4 offset1:116
    ds_write_b32 v71, v70 offset:912
K2_GC7:
    s_mov_b64 exec, s[70:71]
    v_add_u32 v112, v112, v128
    v_lshl_add_u32 v75, v112, 2, v75
    ds_write2_b32 v75, v72, v73 offset0:4 offset1:116
    ds_write_b32 v75, v74 offset:912
    s_mov_b64 exec, s[72:73]
    s_cbranch_execz K2_GC9
    v_add_u32 v113, v113, v129
    v_lshl_add_u32 v79, v113, 2, v79
    ds_write2_b32 v79, v76, v77 offset0:4 offset1:116
    ds_write_b32 v79, v78 offset:912
K2_GC9:
    s_mov_b64 exec, s[74:75]
    v_add_u32 v114, v114, v130
    v_lshl_add_u32 v83, v114, 2, v83
    ds_write2_b32 v83, v80, v81 offset0:4 offset1:116
    ds_write_b32 v83, v82 offset:912
    s_mov_b64 exec, s[76:77]
    s_cbranch_execz K2_GC11
    v_add_u32 v115, v115, v131
    v_lshl_add_u32 v87, v115, 2, v87
    ds_write2_b32 v87, v84, v85 offset0:4 offset1:116
    ds_write_b32 v87, v86 offset:912
K2_GC11:
    s_mov_b64 exec, s[78:79]
    v_add_u32 v116, v116, v132
    v_lshl_add_u32 v91, v116, 2, v91
    ds_write2_b32 v91, v88, v89 offset0:4 offset1:116
    ds_write_b32 v91, v90 offset:912
    s_mov_b64 exec, s[80:81]
    s_cbranch_execz K2_GC13
    v_add_u32 v117, v117, v133
    v_lshl_add_u32 v95, v117, 2, v95
    ds_write2_b32 v95, v92, v93 offset0:4 offset1:116
    ds_write_b32 v95, v94 offset:912
K2_GC13:
    s_mov_b64 exec, s[82:83]
    v_add_u32 v118, v118, v134
    v_lshl_add_u32 v99, v118, 2, v99
    ds_write2_b32 v99, v96, v97 offset0:4 offset1:116
    ds_write_b32 v99, v98 offset:912
    s_mov_b64 exec, s[84:85]
    s_cbranch_execz K2_GC15
    v_add_u32 v119, v119, v135
    v_lshl_add_u32 v103, v119, 2, v103
    ds_write2_b32 v103, v100, v101 offset0:4 offset1:116
    ds_write_b32 v103, v102 offset:912
K2_GC15:
    s_mov_b64 exec, -1
    v_add_u32 v8, 16, v1
    s_mov_b32 s45, 32
K2_XLB:
    v_cmp_lt_u32 vcc, s45, v9
    s_cbranch_vccz K2_XDB
    s_mul_i32 s44, s45, 12
    s_add_u32 s44, s44, 16777216
    v_cmp_lt_u32_sdwa vcc, v8, v12 src0_sel:DWORD src1_sel:WORD_1
    s_and_saveexec_b64 s[46:47], vcc
    s_cbranch_execz K2_XSB0
    buffer_load_dwordx3 v[136:138], v28, s[16:19], s44 offen sc1
    s_waitcnt vmcnt(0)
    v_lshrrev_b32 v139, 26, v138
    v_lshl_add_u32 v3, v139, 2, s90
    ds_read_b32 v4, v3 offset:5120
    ds_add_rtn_u32 v3, v3, v2 offset:1280
    v_mul_u32_u24 v139, 1424, v139
    s_waitcnt lgkmcnt(0)
    v_add_u32 v4, v4, v3
    v_lshl_add_u32 v139, v4, 2, v139
    ds_write2_b32 v139, v136, v137 offset0:4 offset1:116
    ds_write_b32 v139, v138 offset:912
K2_XSB0:
    s_mov_b64 exec, -1
    s_add_u32 s44, s44, 1228800
    v_cmp_lt_u32_sdwa vcc, v8, v14 src0_sel:DWORD src1_sel:WORD_1
    s_and_saveexec_b64 s[46:47], vcc
    s_cbranch_execz K2_XSB1
    buffer_load_dwordx3 v[136:138], v29, s[16:19], s44 offen sc1
    s_waitcnt vmcnt(0)
    v_lshrrev_b32 v139, 26, v138
    v_lshl_add_u32 v3, v139, 2, s90
    ds_read_b32 v4, v3 offset:5120
    ds_add_rtn_u32 v3, v3, v2 offset:1280
    v_mul_u32_u24 v139, 1424, v139
    s_waitcnt lgkmcnt(0)
    v_add_u32 v4, v4, v3
    v_lshl_add_u32 v139, v4, 2, v139
    ds_write2_b32 v139, v136, v137 offset0:4 offset1:116
    ds_write_b32 v139, v138 offset:912
K2_XSB1:
    s_mov_b64 exec, -1
    s_add_u32 s44, s44, 1228800
    v_cmp_lt_u32_sdwa vcc, v8, v16 src0_sel:DWORD src1_sel:WORD_1
    s_and_saveexec_b64 s[46:47], vcc
    s_cbranch_execz K2_XSB2
    buffer_load_dwordx3 v[136:138], v30, s[16:19], s44 offen sc1
    s_waitcnt vmcnt(0)
    v_lshrrev_b32 v139, 26, v138
    v_lshl_add_u32 v3, v139, 2, s90
    ds_read_b32 v4, v3 offset:5120
    ds_add_rtn_u32 v3, v3, v2 offset:1280
    v_mul_u32_u24 v139, 1424, v139
    s_waitcnt lgkmcnt(0)
    v_add_u32 v4, v4, v3
    v_lshl_add_u32 v139, v4, 2, v139
    ds_write2_b32 v139, v136, v137 offset0:4 offset1:116
    ds_write_b32 v139, v138 offset:912
K2_XSB2:
    s_mov_b64 exec, -1
    s_add_u32 s44, s44, 1228800
    v_cmp_lt_u32_sdwa vcc, v8, v18 src0_sel:DWORD src1_sel:WORD_1
    s_and_saveexec_b64 s[46:47], vcc
    s_cbranch_execz K2_XSB3
    buffer_load_dwordx3 v[136:138], v31, s[16:19], s44 offen sc1
    s_waitcnt vmcnt(0)
    v_lshrrev_b32 v139, 26, v138
    v_lshl_add_u32 v3, v139, 2, s90
    ds_read_b32 v4, v3 offset:5120
    ds_add_rtn_u32 v3, v3, v2 offset:1280
    v_mul_u32_u24 v139, 1424, v139
    s_waitcnt lgkmcnt(0)
    v_add_u32 v4, v4, v3
    v_lshl_add_u32 v139, v4, 2, v139
    ds_write2_b32 v139, v136, v137 offset0:4 offset1:116
    ds_write_b32 v139, v138 offset:912
K2_XSB3:
    s_mov_b64 exec, -1
    s_add_u32 s44, s44, 1228800
    v_cmp_lt_u32_sdwa vcc, v8, v20 src0_sel:DWORD src1_sel:WORD_1
    s_and_saveexec_b64 s[46:47], vcc
    s_cbranch_execz K2_XSB4
    buffer_load_dwordx3 v[136:138], v32, s[16:19], s44 offen sc1
    s_waitcnt vmcnt(0)
    v_lshrrev_b32 v139, 26, v138
    v_lshl_add_u32 v3, v139, 2, s90
    ds_read_b32 v4, v3 offset:5120
    ds_add_rtn_u32 v3, v3, v2 offset:1280
    v_mul_u32_u24 v139, 1424, v139
    s_waitcnt lgkmcnt(0)
    v_add_u32 v4, v4, v3
    v_lshl_add_u32 v139, v4, 2, v139
    ds_write2_b32 v139, v136, v137 offset0:4 offset1:116
    ds_write_b32 v139, v138 offset:912
K2_XSB4:
    s_mov_b64 exec, -1
    s_add_u32 s44, s44, 1228800
    v_cmp_lt_u32_sdwa vcc, v8, v22 src0_sel:DWORD src1_sel:WORD_1
    s_and_saveexec_b64 s[46:47], vcc
    s_cbranch_execz K2_XSB5
    buffer_load_dwordx3 v[136:138], v33, s[16:19], s44 offen sc1
    s_waitcnt vmcnt(0)
    v_lshrrev_b32 v139, 26, v138
    v_lshl_add_u32 v3, v139, 2, s90
    ds_read_b32 v4, v3 offset:5120
    ds_add_rtn_u32 v3, v3, v2 offset:1280
    v_mul_u32_u24 v139, 1424, v139
    s_waitcnt lgkmcnt(0)
    v_add_u32 v4, v4, v3
    v_lshl_add_u32 v139, v4, 2, v139
    ds_write2_b32 v139, v136, v137 offset0:4 offset1:116
    ds_write_b32 v139, v138 offset:912
K2_XSB5:
    s_mov_b64 exec, -1
    s_add_u32 s44, s44, 1228800
    v_cmp_lt_u32_sdwa vcc, v8, v24 src0_sel:DWORD src1_sel:WORD_1
    s_and_saveexec_b64 s[46:47], vcc
    s_cbranch_execz K2_XSB6
    buffer_load_dwordx3 v[136:138], v34, s[16:19], s44 offen sc1
    s_waitcnt vmcnt(0)
    v_lshrrev_b32 v139, 26, v138
    v_lshl_add_u32 v3, v139, 2, s90
    ds_read_b32 v4, v3 offset:5120
    ds_add_rtn_u32 v3, v3, v2 offset:1280
    v_mul_u32_u24 v139, 1424, v139
    s_waitcnt lgkmcnt(0)
    v_add_u32 v4, v4, v3
    v_lshl_add_u32 v139, v4, 2, v139
    ds_write2_b32 v139, v136, v137 offset0:4 offset1:116
    ds_write_b32 v139, v138 offset:912
K2_XSB6:
    s_mov_b64 exec, -1
    s_add_u32 s44, s44, 1228800
    v_cmp_lt_u32_sdwa vcc, v8, v26 src0_sel:DWORD src1_sel:WORD_1
    s_and_saveexec_b64 s[46:47], vcc
    s_cbranch_execz K2_XSB7
    buffer_load_dwordx3 v[136:138], v35, s[16:19], s44 offen sc1
    s_waitcnt vmcnt(0)
    v_lshrrev_b32 v139, 26, v138
    v_lshl_add_u32 v3, v139, 2, s90
    ds_read_b32 v4, v3 offset:5120
    ds_add_rtn_u32 v3, v3, v2 offset:1280
    v_mul_u32_u24 v139, 1424, v139
    s_waitcnt lgkmcnt(0)
    v_add_u32 v4, v4, v3
    v_lshl_add_u32 v139, v4, 2, v139
    ds_write2_b32 v139, v136, v137 offset0:4 offset1:116
    ds_write_b32 v139, v138 offset:912
K2_XSB7:
    s_mov_b64 exec, -1
    s_add_u32 s44, s44, 1228800
    s_add_u32 s45, s45, 16
    v_add_u32 v8, 16, v8
    s_branch K2_XLB
K2_XDB:
    s_waitcnt vmcnt(1) lgkmcnt(0)
    s_barrier
    s_mov_b64 s[48:49], 0
    s_mov_b32 s53, 0
    s_mov_b32 s54, 0
    s_mov_b32 s59, 70752
    s_mov_b32 vcc_lo, 0xffff0000
    s_mov_b32 vcc_hi, 0xffff0000
    s_cmp_eq_u32 s54, 1
    s_cbranch_scc1 FB_P0
    s_cmp_eq_u32 s54, 2
    s_cbranch_scc1 FC_P0
    s_mov_b32 s55, 0
    s_mov_b64 exec, 1
    ds_add_rtn_u32 v228, v245, v243 offset:0
    s_mov_b64 exec, -1
    s_waitcnt lgkmcnt(0)
    v_readfirstlane_b32 s44, v228
    s_lshr_b32 s44, s44, 5
    s_min_u32 s44, s44, 62
    s_add_u32 s45, s44, 1
    s_nop 0
    v_readlane_b32 s56, v247, s44
    v_readlane_b32 s57, v247, s45
    s_mov_b32 s44, s56
    s_and_b32 s45, s57, 7
    s_cbranch_scc0 FN_P0
    s_mov_b32 s54, 1
    s_bfe_u32 s45, s56, 0x20001
    s_cbranch_scc0 FN_P0
    s_mov_b32 s55, 2
    s_and_b32 s46, s56, 0xfff8
    s_lshl_b32 s37, s46, 1
    s_sub_u32 s38, s45, 1
    s_mov_b32 s39, 4
    s_or_b32 s46, s46, s45
    s_bitset1_b32 s46, 16
    s_branch FP_P0
FC_P0:
    s_mov_b32 s54, 0
    s_bfe_u32 s45, s56, 0x20001
    s_and_b32 s46, s56, 0xfff8
    s_lshl_b32 s44, s45, 5
    s_add_u32 s44, s44, s46
    s_lshl_b32 s37, s44, 1
    s_and_b32 s46, s56, 0xffff
    s_sub_u32 s46, s46, s45
    s_lshr_b32 s44, s56, 20
    s_sub_u32 s38, s44, s45
    s_bfe_u32 s39, s56, 0x30010
    s_bitset1_b32 s46, 17
    s_branch FP_P0
FB_P0:
    s_mov_b32 s54, s55
    s_mov_b32 s44, s57
FN_P0:
    s_and_b32 s37, s44, 0xfff8
    s_lshl_b32 s37, s37, 1
    s_bfe_u32 s39, s44, 0x30010
    s_lshr_b32 s38, s44, 20
    s_and_b32 s46, s44, 0xffff
FP_P0:
    s_mov_b32 s47, 0
    s_lshl_b64 s[46:47], s[46:47], s53
    s_or_b64 s[48:49], s[48:49], s[46:47]
    s_add_u32 s53, s53, 20
    s_and_b32 s44, s48, 7
    s_cbranch_scc0 K2_DONE
    v_add_u32 v248, s37, v242
    ds_read2_b32 v[234:235], v248 offset0:0 offset1:112
    ds_read_b32 v236, v248 offset:896
    v_add_u32 v248, s37, v243
    ds_read_b32 v249, v248 offset:384
    s_waitcnt lgkmcnt(0)
    v_lshlrev_b32_sdwa v249, 9, v249 dst_sel:DWORD dst_unused:UNUSED_PAD src0_sel:DWORD src1_sel:WORD_1
    v_and_or_b32 v248, v236, s52, v245
    s_mov_b32 m0, s43
    s_mov_b64 exec, s[50:51]
    buffer_load_dwordx4 v248, s[12:15], 0 offen  lds
    s_mov_b64 exec, -1
    s_mov_b32 m0, s42
    v_add_u32_dpp v248, v249, v244 row_newbcast:0 row_mask:0xf bank_mask:0xf
    buffer_load_dwordx4 v248, s[8:11], s5 offen offset:0  lds
    v_add_u32_dpp v248, v249, v244 row_newbcast:1 row_mask:0xf bank_mask:0xf
    buffer_load_dwordx4 v248, s[8:11], s6 offen offset:1024  lds
    v_add_u32_dpp v248, v249, v244 row_newbcast:2 row_mask:0xf bank_mask:0xf
    buffer_load_dwordx4 v248, s[8:11], s7 offen offset:2048  lds
    v_add_u32_dpp v248, v249, v244 row_newbcast:3 row_mask:0xf bank_mask:0xf
    buffer_load_dwordx4 v248, s[8:11], 0 offen offset:3072  lds
    s_mov_b32 m0, s4
    v_add_u32_dpp v248, v249, v244 row_newbcast:0 row_mask:0xf bank_mask:0xf
    buffer_load_dwordx4 v248, s[8:11], s94 offen offset:0  lds
    v_add_u32_dpp v248, v249, v244 row_newbcast:1 row_mask:0xf bank_mask:0xf
    buffer_load_dwordx4 v248, s[8:11], s95 offen offset:1024  lds
    v_add_u32_dpp v248, v249, v244 row_newbcast:2 row_mask:0xf bank_mask:0xf
    buffer_load_dwordx4 v248, s[8:11], s96 offen offset:2048  lds
    v_add_u32_dpp v248, v249, v244 row_newbcast:3 row_mask:0xf bank_mask:0xf
    buffer_load_dwordx4 v248, s[8:11], s97 offen offset:3072  lds
    s_mov_b32 s40, 4
    s_add_u32 s37, s37, 64
    s_sub_u32 s38, s38, 1
    s_cbranch_scc0 AD_P1
    s_mov_b32 s40, s39
    s_cmp_eq_u32 s54, 1
    s_cbranch_scc1 FB_P1
    s_cmp_eq_u32 s54, 2
    s_cbranch_scc1 FC_P1
    s_mov_b32 s55, 0
    s_mov_b64 exec, 1
    ds_add_rtn_u32 v228, v245, v243 offset:0
    s_mov_b64 exec, -1
    s_waitcnt lgkmcnt(0)
    v_readfirstlane_b32 s44, v228
    s_lshr_b32 s44, s44, 5
    s_min_u32 s44, s44, 62
    s_add_u32 s45, s44, 1
    s_nop 0
    v_readlane_b32 s56, v247, s44
    v_readlane_b32 s57, v247, s45
    s_mov_b32 s44, s56
    s_and_b32 s45, s57, 7
    s_cbranch_scc0 FN_P1
    s_mov_b32 s54, 1
    s_bfe_u32 s45, s56, 0x20001
    s_cbranch_scc0 FN_P1
    s_mov_b32 s55, 2
    s_and_b32 s46, s56, 0xfff8
    s_lshl_b32 s37, s46, 1
    s_sub_u32 s38, s45, 1
    s_mov_b32 s39, 4
    s_or_b32 s46, s46, s45
    s_bitset1_b32 s46, 16
    s_branch FP_P1
FC_P1:
    s_mov_b32 s54, 0
    s_bfe_u32 s45, s56, 0x20001
    s_and_b32 s46, s56, 0xfff8
    s_lshl_b32 s44, s45, 5
    s_add_u32 s44, s44, s46
    s_lshl_b32 s37, s44, 1
    s_and_b32 s46, s56, 0xffff
    s_sub_u32 s46, s46, s45
    s_lshr_b32 s44, s56, 20
    s_sub_u32 s38, s44, s45
    s_bfe_u32 s39, s56, 0x30010
    s_bitset1_b32 s46, 17
    s_branch FP_P1
FB_P1:
    s_mov_b32 s54, s55
    s_mov_b32 s44, s57
FN_P1:
    s_and_b32 s37, s44, 0xfff8
    s_lshl_b32 s37, s37, 1
    s_bfe_u32 s39, s44, 0x30010
    s_lshr_b32 s38, s44, 20
    s_and_b32 s46, s44, 0xffff
FP_P1:
    s_mov_b32 s47, 0
    s_lshl_b64 s[46:47], s[46:47], s53
    s_or_b64 s[48:49], s[48:49], s[46:47]
    s_add_u32 s53, s53, 20
AD_P1:
    v_cndmask_b32_sdwa v232, 1.0, v235, vcc dst_sel:WORD_1 dst_unused:UNUSED_PAD src0_sel:WORD_1 src1_sel:WORD_0
    v_cndmask_b32_sdwa v233, v234, v234, vcc dst_sel:WORD_1 dst_unused:UNUSED_PAD src0_sel:WORD_0 src1_sel:WORD_1
    v_add_u32 v248, s37, v242
    ds_read2_b32 v[234:235], v248 offset0:0 offset1:112
    ds_read_b32 v236, v248 offset:896
    v_add_u32 v248, s37, v243
    ds_read_b32 v249, v248 offset:384
    s_waitcnt lgkmcnt(0)
    s_mov_b32 s40, 4
    s_add_u32 s37, s37, 64
    s_sub_u32 s38, s38, 1
    s_cbranch_scc0 AD_P2
    s_mov_b32 s40, s39
    s_cmp_eq_u32 s54, 1
    s_cbranch_scc1 FB_P2
    s_cmp_eq_u32 s54, 2
    s_cbranch_scc1 FC_P2
    s_mov_b32 s55, 0
    s_mov_b64 exec, 1
    ds_add_rtn_u32 v228, v245, v243 offset:0
    s_mov_b64 exec, -1
    s_waitcnt lgkmcnt(0)
    v_readfirstlane_b32 s44, v228
    s_lshr_b32 s44, s44, 5
    s_min_u32 s44, s44, 62
    s_add_u32 s45, s44, 1
    s_nop 0
    v_readlane_b32 s56, v247, s44
    v_readlane_b32 s57, v247, s45
    s_mov_b32 s44, s56
    s_and_b32 s45, s57, 7
    s_cbranch_scc0 FN_P2
    s_mov_b32 s54, 1
    s_bfe_u32 s45, s56, 0x20001
    s_cbranch_scc0 FN_P2
    s_mov_b32 s55, 2
    s_and_b32 s46, s56, 0xfff8
    s_lshl_b32 s37, s46, 1
    s_sub_u32 s38, s45, 1
    s_mov_b32 s39, 4
    s_or_b32 s46, s46, s45
    s_bitset1_b32 s46, 16
    s_branch FP_P2
FC_P2:
    s_mov_b32 s54, 0
    s_bfe_u32 s45, s56, 0x20001
    s_and_b32 s46, s56, 0xfff8
    s_lshl_b32 s44, s45, 5
    s_add_u32 s44, s44, s46
    s_lshl_b32 s37, s44, 1
    s_and_b32 s46, s56, 0xffff
    s_sub_u32 s46, s46, s45
    s_lshr_b32 s44, s56, 20
    s_sub_u32 s38, s44, s45
    s_bfe_u32 s39, s56, 0x30010
    s_bitset1_b32 s46, 17
    s_branch FP_P2
FB_P2:
    s_mov_b32 s54, s55
    s_mov_b32 s44, s57
FN_P2:
    s_and_b32 s37, s44, 0xfff8
    s_lshl_b32 s37, s37, 1
    s_bfe_u32 s39, s44, 0x30010
    s_lshr_b32 s38, s44, 20
    s_and_b32 s46, s44, 0xffff
FP_P2:
    s_mov_b32 s47, 0
    s_lshl_b64 s[46:47], s[46:47], s53
    s_or_b64 s[48:49], s[48:49], s[46:47]
    s_add_u32 s53, s53, 20
AD_P2:
    v_lshlrev_b32_sdwa v249, 9, v249 dst_sel:DWORD dst_unused:UNUSED_PAD src0_sel:DWORD src1_sel:WORD_1
    v_mov_b64 v[64:65], 0
    v_mov_b64 v[66:67], 0
    v_mov_b64 v[68:69], 0
    v_mov_b64 v[70:71], 0
    v_mov_b64 v[152:153], 0
    v_mov_b64 v[154:155], 0
    v_mov_b64 v[156:157], 0
    v_mov_b64 v[158:159], 0
    s_and_b32 s35, s48, 0xfff8
    s_lshl_b32 s35, s35, 1
    s_and_b32 s36, s48, 7
    s_bfe_u32 s58, s48, 0x20010
    s_lshr_b64 s[48:49], s[48:49], 20
    s_sub_u32 s53, s53, 20
    s_sub_u32 s36, s36, 1
    s_waitcnt vmcnt(4)
    ds_read_b64_tr_b16 v[176:177], v237 offset:0
    ds_read_b64_tr_b16 v[178:179], v237 offset:2048
    ds_read_b64_tr_b16 v[180:181], v238 offset:0
    ds_read_b64_tr_b16 v[182:183], v238 offset:2048
    ds_read_b64_tr_b16 v[184:185], v239 offset:0
    ds_read_b64_tr_b16 v[186:187], v239 offset:2048
    ds_read_b64_tr_b16 v[188:189], v240 offset:0
    ds_read_b64_tr_b16 v[190:191], v240 offset:2048
    ds_read_u16_d16_hi v220, v241 offset:0
    ds_read_u16_d16_hi v221, v241 offset:16
    ds_read_u16_d16_hi v222, v241 offset:32
    ds_read_u16_d16_hi v223, v241 offset:48
    ds_read_u16_d16_hi v224, v241 offset:64
    ds_read_u16_d16_hi v225, v241 offset:80
    ds_read_u16_d16_hi v226, v241 offset:96
    ds_read_u16_d16_hi v227, v241 offset:112
    s_mov_b32 m0, s42
    s_waitcnt lgkmcnt(8)
    s_cmp_gt_u32 s40, 0
    s_cbranch_scc0 DX_P_00
    v_add_u32_dpp v248, v249, v244 row_newbcast:0 row_mask:0xf bank_mask:0xf
    buffer_load_dwordx4 v248, s[8:11], s5 offen offset:0  lds
DX_P_00:
    s_cmp_gt_u32 s40, 1
    s_cbranch_scc0 DX_P_01
    v_add_u32_dpp v248, v249, v244 row_newbcast:1 row_mask:0xf bank_mask:0xf
    buffer_load_dwordx4 v248, s[8:11], s6 offen offset:1024  lds
DX_P_01:
    s_cmp_gt_u32 s40, 2
    s_cbranch_scc0 DX_P_02
    v_add_u32_dpp v248, v249, v244 row_newbcast:2 row_mask:0xf bank_mask:0xf
    buffer_load_dwordx4 v248, s[8:11], s7 offen offset:2048  lds
DX_P_02:
    s_cmp_gt_u32 s40, 3
    s_cbranch_scc0 DX_P_03
    v_add_u32_dpp v248, v249, v244 row_newbcast:3 row_mask:0xf bank_mask:0xf
    buffer_load_dwordx4 v248, s[8:11], 0 offen offset:3072  lds
DX_P_03:
    s_waitcnt lgkmcnt(0)
    v_and_or_b32 v248, v236, s52, v245
    s_mov_b32 m0, s43
    s_mov_b64 exec, s[50:51]
    buffer_load_dwordx4 v248, s[12:15], 0 offen  lds
    s_mov_b64 exec, -1
    s_cmp_eq_u32 s40, 4
    s_cbranch_scc1 VW_P
    s_waitcnt vmcnt(1)
VW_P:
    s_waitcnt vmcnt(5)
    ds_read_b64_tr_b16 v[192:193], v237 offset:4096
    ds_read_b64_tr_b16 v[194:195], v237 offset:6144
    ds_read_b64_tr_b16 v[196:197], v238 offset:4096
    ds_read_b64_tr_b16 v[198:199], v238 offset:6144
    ds_read_b64_tr_b16 v[200:201], v239 offset:4096
    ds_read_b64_tr_b16 v[202:203], v239 offset:6144
    ds_read_b64_tr_b16 v[204:205], v240 offset:4096
    ds_read_b64_tr_b16 v[206:207], v240 offset:6144
    v_mul_f32_dpp v228, v232, v220 row_newbcast:0 row_mask:0xf bank_mask:0xf
    v_mul_f32_dpp v229, v232, v221 row_newbcast:1 row_mask:0xf bank_mask:0xf
    v_cvt_pk_bf16_f32 v208, v228, v229
    v_mul_f32_dpp v230, v232, v222 row_newbcast:2 row_mask:0xf bank_mask:0xf
    v_mul_f32_dpp v231, v232, v223 row_newbcast:3 row_mask:0xf bank_mask:0xf
    v_cvt_pk_bf16_f32 v209, v230, v231
    v_mul_f32_dpp v228, v232, v224 row_newbcast:4 row_mask:0xf bank_mask:0xf
    v_mul_f32_dpp v229, v232, v225 row_newbcast:5 row_mask:0xf bank_mask:0xf
    v_cvt_pk_bf16_f32 v210, v228, v229
    v_mul_f32_dpp v230, v232, v226 row_newbcast:6 row_mask:0xf bank_mask:0xf
    v_mul_f32_dpp v231, v232, v227 row_newbcast:7 row_mask:0xf bank_mask:0xf
    v_cvt_pk_bf16_f32 v211, v230, v231
    s_waitcnt lgkmcnt(0)
    s_mov_b32 m0, s4
    s_cmp_gt_u32 s40, 0
    s_cbranch_scc0 DX_P_10
    v_add_u32_dpp v248, v249, v244 row_newbcast:0 row_mask:0xf bank_mask:0xf
    buffer_load_dwordx4 v248, s[8:11], s94 offen offset:0  lds
DX_P_10:
    s_cmp_gt_u32 s40, 1
    s_cbranch_scc0 DX_P_11
    v_add_u32_dpp v248, v249, v244 row_newbcast:1 row_mask:0xf bank_mask:0xf
    buffer_load_dwordx4 v248, s[8:11], s95 offen offset:1024  lds
DX_P_11:
    s_cmp_gt_u32 s40, 2
    s_cbranch_scc0 DX_P_12
    v_add_u32_dpp v248, v249, v244 row_newbcast:2 row_mask:0xf bank_mask:0xf
    buffer_load_dwordx4 v248, s[8:11], s96 offen offset:2048  lds
DX_P_12:
    s_cmp_gt_u32 s40, 3
    s_cbranch_scc0 DX_P_13
    v_add_u32_dpp v248, v249, v244 row_newbcast:3 row_mask:0xf bank_mask:0xf
    buffer_load_dwordx4 v248, s[8:11], s97 offen offset:3072  lds
DX_P_13:
K2_SEL:
    s_cmp_eq_u32 s40, 4
    s_cbranch_scc0 K2_FP
    v_mfma_f32_32x32x16_bf16 v[0:15], v[208:211], v[176:179], 0
    v_mul_f32_dpp v228, v233, v220 row_newbcast:0 row_mask:0xf bank_mask:0xf
    v_mul_f32_dpp v229, v233, v221 row_newbcast:1 row_mask:0xf bank_mask:0xf
    v_cvt_pk_bf16_f32 v212, v228, v229
    v_mul_f32_dpp v230, v233, v222 row_newbcast:2 row_mask:0xf bank_mask:0xf
    v_mfma_f32_32x32x16_bf16 v[88:103], v[208:211], v[180:183], 0
    v_mul_f32_dpp v231, v233, v223 row_newbcast:3 row_mask:0xf bank_mask:0xf
    v_cvt_pk_bf16_f32 v213, v230, v231
    v_mul_f32_dpp v228, v233, v224 row_newbcast:4 row_mask:0xf bank_mask:0xf
    v_mul_f32_dpp v229, v233, v225 row_newbcast:5 row_mask:0xf bank_mask:0xf
    v_mfma_f32_32x32x16_bf16 v[32:47], v[208:211], v[184:187], 0
    v_cvt_pk_bf16_f32 v214, v228, v229
    v_mul_f32_dpp v230, v233, v226 row_newbcast:6 row_mask:0xf bank_mask:0xf
    v_mul_f32_dpp v231, v233, v227 row_newbcast:7 row_mask:0xf bank_mask:0xf
    v_cvt_pk_bf16_f32 v215, v230, v231
    v_mfma_f32_32x32x16_bf16 v[120:135], v[208:211], v[188:191], 0
    ds_swizzle_b32 v216, v208 offset:0x401f
    ds_swizzle_b32 v217, v209 offset:0x401f
    ds_swizzle_b32 v218, v210 offset:0x401f
    ds_swizzle_b32 v219, v211 offset:0x401f
    v_mfma_f32_32x32x16_bf16 v[16:31], v[212:215], v[176:179], 0
    v_cndmask_b32_sdwa v232, 1.0, v235, vcc dst_sel:WORD_1 dst_unused:UNUSED_PAD src0_sel:WORD_1 src1_sel:WORD_0
    v_cndmask_b32_sdwa v233, v234, v234, vcc dst_sel:WORD_1 dst_unused:UNUSED_PAD src0_sel:WORD_0 src1_sel:WORD_1
    v_mfma_f32_32x32x16_bf16 v[104:119], v[212:215], v[180:183], 0
    v_add_u32 v248, s37, v242
    ds_read2_b32 v[234:235], v248 offset0:0 offset1:112
    ds_read_b32 v236, v248 offset:896
    v_add_u32 v248, s37, v243
    ds_read_b32 v249, v248 offset:384
    v_mfma_f32_32x32x16_bf16 v[72:87], v[212:215], v[184:187], 0
    s_waitcnt lgkmcnt(3)
    v_xor_b32 v208, v246, v208
    v_xor_b32 v209, v246, v209
    v_xor_b32 v210, v246, v210
    v_xor_b32 v211, v246, v211
    v_mfma_f32_32x32x16_bf16 v[160:175], v[212:215], v[188:191], 0
    s_nop 1
    v_mfma_f32_32x32x16_bf16 v[48:63], v[216:219], v[192:195], 0
    s_nop 2
    v_mfma_f32_32x32x16_bf16 v[136:151], v[216:219], v[196:199], 0
    ds_swizzle_b32 v216, v212 offset:0x401f
    ds_swizzle_b32 v217, v213 offset:0x401f
    ds_swizzle_b32 v218, v214 offset:0x401f
    ds_swizzle_b32 v219, v215 offset:0x401f
    v_mfma_f32_32x32x16_bf16 v[64:79], v[208:211], v[200:203], v[64:79]
    s_waitcnt vmcnt(5)
    ds_read_b64_tr_b16 v[176:177], v237 offset:0
    ds_read_b64_tr_b16 v[178:179], v237 offset:2048
    ds_read_b64_tr_b16 v[180:181], v238 offset:0
    ds_read_b64_tr_b16 v[182:183], v238 offset:2048
    ds_read_b64_tr_b16 v[184:185], v239 offset:0
    ds_read_b64_tr_b16 v[186:187], v239 offset:2048
    ds_read_b64_tr_b16 v[188:189], v240 offset:0
    ds_read_b64_tr_b16 v[190:191], v240 offset:2048
    v_mfma_f32_32x32x16_bf16 v[152:167], v[208:211], v[204:207], v[152:167]
    s_waitcnt lgkmcnt(8)
    v_lshlrev_b32_sdwa v249, 9, v249 dst_sel:DWORD dst_unused:UNUSED_PAD src0_sel:DWORD src1_sel:WORD_1
    s_add_u32 s37, s37, 64
    s_sub_u32 s38, s38, 1
    s_cbranch_scc1 K2_OUT
    s_mov_b32 m0, s42
    s_waitcnt lgkmcnt(0)
    v_add_u32_dpp v248, v249, v244 row_newbcast:0 row_mask:0xf bank_mask:0xf
    buffer_load_dwordx4 v248, s[8:11], s5 offen offset:0  lds
    v_add_u32_dpp v248, v249, v244 row_newbcast:1 row_mask:0xf bank_mask:0xf
    buffer_load_dwordx4 v248, s[8:11], s6 offen offset:1024  lds
    v_add_u32_dpp v248, v249, v244 row_newbcast:2 row_mask:0xf bank_mask:0xf
    buffer_load_dwordx4 v248, s[8:11], s7 offen offset:2048  lds
    v_add_u32_dpp v248, v249, v244 row_newbcast:3 row_mask:0xf bank_mask:0xf
    buffer_load_dwordx4 v248, s[8:11], 0 offen offset:3072  lds
    v_mfma_f32_32x32x16_bf16 v[40:55], v[212:215], v[200:203], v[40:55]
    s_waitcnt vmcnt(8)
    ds_read_u16_d16_hi v220, v241 offset:0
    ds_read_u16_d16_hi v221, v241 offset:16
    ds_read_u16_d16_hi v222, v241 offset:32
    ds_read_u16_d16_hi v223, v241 offset:48
    ds_read_u16_d16_hi v224, v241 offset:64
    ds_read_u16_d16_hi v225, v241 offset:80
    ds_read_u16_d16_hi v226, v241 offset:96
    ds_read_u16_d16_hi v227, v241 offset:112
    v_xor_b32 v216, v246, v216
    v_xor_b32 v217, v246, v217
    v_xor_b32 v218, v246, v218
    v_xor_b32 v219, v246, v219
    v_mfma_f32_32x32x16_bf16 v[128:143], v[212:215], v[204:207], v[128:143]
    s_waitcnt lgkmcnt(0)
    v_and_or_b32 v248, v236, s52, v245
    s_mov_b32 m0, s43
    s_mov_b64 exec, s[50:51]
    buffer_load_dwordx4 v248, s[12:15], 0 offen  lds
    s_mov_b64 exec, -1
    v_mul_f32_dpp v228, v232, v220 row_newbcast:0 row_mask:0xf bank_mask:0xf
    v_mul_f32_dpp v229, v232, v221 row_newbcast:1 row_mask:0xf bank_mask:0xf
    v_cvt_pk_bf16_f32 v208, v228, v229
    v_mfma_f32_32x32x16_bf16 v[72:87], v[216:219], v[192:195], v[72:87]
    v_mul_f32_dpp v230, v232, v222 row_newbcast:2 row_mask:0xf bank_mask:0xf
    v_mul_f32_dpp v231, v232, v223 row_newbcast:3 row_mask:0xf bank_mask:0xf
    v_cvt_pk_bf16_f32 v209, v230, v231
    v_mul_f32_dpp v228, v232, v224 row_newbcast:4 row_mask:0xf bank_mask:0xf
    v_mul_f32_dpp v229, v232, v225 row_newbcast:5 row_mask:0xf bank_mask:0xf
    v_cvt_pk_bf16_f32 v210, v228, v229
    v_mul_f32_dpp v230, v232, v226 row_newbcast:6 row_mask:0xf bank_mask:0xf
    v_mul_f32_dpp v231, v232, v227 row_newbcast:7 row_mask:0xf bank_mask:0xf
    v_cvt_pk_bf16_f32 v211, v230, v231
    s_sub_u32 s36, s36, 1
    v_mfma_f32_32x32x16_bf16 v[160:175], v[216:219], v[196:199], v[160:175]
    s_cbranch_scc1 K2_CON
K2_RF:
    v_mfma_f32_32x32x16_bf16 v[0:15], v[208:211], v[176:179], v[0:15]
    v_mul_f32_dpp v228, v233, v220 row_newbcast:0 row_mask:0xf bank_mask:0xf
    v_mul_f32_dpp v229, v233, v221 row_newbcast:1 row_mask:0xf bank_mask:0xf
    v_cvt_pk_bf16_f32 v212, v228, v229
    v_mul_f32_dpp v230, v233, v222 row_newbcast:2 row_mask:0xf bank_mask:0xf
    v_mfma_f32_32x32x16_bf16 v[88:103], v[208:211], v[180:183], v[88:103]
    v_mul_f32_dpp v231, v233, v223 row_newbcast:3 row_mask:0xf bank_mask:0xf
    v_cvt_pk_bf16_f32 v213, v230, v231
    v_mul_f32_dpp v228, v233, v224 row_newbcast:4 row_mask:0xf bank_mask:0xf
    v_mul_f32_dpp v229, v233, v225 row_newbcast:5 row_mask:0xf bank_mask:0xf
    v_mfma_f32_32x32x16_bf16 v[32:47], v[208:211], v[184:187], v[32:47]
    v_cvt_pk_bf16_f32 v214, v228, v229
    v_mul_f32_dpp v230, v233, v226 row_newbcast:6 row_mask:0xf bank_mask:0xf
    v_mul_f32_dpp v231, v233, v227 row_newbcast:7 row_mask:0xf bank_mask:0xf
    v_cvt_pk_bf16_f32 v215, v230, v231
    v_mfma_f32_32x32x16_bf16 v[120:135], v[208:211], v[188:191], v[120:135]
    s_waitcnt vmcnt(5)
    ds_read_b64_tr_b16 v[192:193], v237 offset:4096
    ds_read_b64_tr_b16 v[194:195], v237 offset:6144
    ds_read_b64_tr_b16 v[196:197], v238 offset:4096
    ds_read_b64_tr_b16 v[198:199], v238 offset:6144
    ds_read_b64_tr_b16 v[200:201], v239 offset:4096
    ds_read_b64_tr_b16 v[202:203], v239 offset:6144
    ds_read_b64_tr_b16 v[204:205], v240 offset:4096
    ds_read_b64_tr_b16 v[206:207], v240 offset:6144
    v_mfma_f32_32x32x16_bf16 v[16:31], v[212:215], v[176:179], v[16:31]
    ds_swizzle_b32 v216, v208 offset:0x401f
    ds_swizzle_b32 v217, v209 offset:0x401f
    ds_swizzle_b32 v218, v210 offset:0x401f
    ds_swizzle_b32 v219, v211 offset:0x401f
    s_mov_b32 m0, s4
    v_mfma_f32_32x32x16_bf16 v[104:119], v[212:215], v[180:183], v[104:119]
    s_waitcnt lgkmcnt(4)
    v_add_u32_dpp v248, v249, v244 row_newbcast:0 row_mask:0xf bank_mask:0xf
    buffer_load_dwordx4 v248, s[8:11], s94 offen offset:0  lds
    v_add_u32_dpp v248, v249, v244 row_newbcast:1 row_mask:0xf bank_mask:0xf
    buffer_load_dwordx4 v248, s[8:11], s95 offen offset:1024  lds
    v_add_u32_dpp v248, v249, v244 row_newbcast:2 row_mask:0xf bank_mask:0xf
    buffer_load_dwordx4 v248, s[8:11], s96 offen offset:2048  lds
    v_add_u32_dpp v248, v249, v244 row_newbcast:3 row_mask:0xf bank_mask:0xf
    buffer_load_dwordx4 v248, s[8:11], s97 offen offset:3072  lds
    v_cndmask_b32_sdwa v232, 1.0, v235, vcc dst_sel:WORD_1 dst_unused:UNUSED_PAD src0_sel:WORD_1 src1_sel:WORD_0
    v_cndmask_b32_sdwa v233, v234, v234, vcc dst_sel:WORD_1 dst_unused:UNUSED_PAD src0_sel:WORD_0 src1_sel:WORD_1
    v_mfma_f32_32x32x16_bf16 v[72:87], v[212:215], v[184:187], v[72:87]
    v_add_u32 v248, s37, v242
    ds_read2_b32 v[234:235], v248 offset0:0 offset1:112
    ds_read_b32 v236, v248 offset:896
    v_add_u32 v248, s37, v243
    ds_read_b32 v249, v248 offset:384
    v_mfma_f32_32x32x16_bf16 v[160:175], v[212:215], v[188:191], v[160:175]
    s_waitcnt lgkmcnt(3)
    v_xor_b32 v208, v246, v208
    v_xor_b32 v209, v246, v209
    v_xor_b32 v210, v246, v210
    v_xor_b32 v211, v246, v211
    v_mfma_f32_32x32x16_bf16 v[48:63], v[216:219], v[192:195], v[48:63]
    v_mfma_f32_32x32x16_bf16 v[136:151], v[216:219], v[196:199], v[136:151]
    ds_swizzle_b32 v216, v212 offset:0x401f
    ds_swizzle_b32 v217, v213 offset:0x401f
    ds_swizzle_b32 v218, v214 offset:0x401f
    ds_swizzle_b32 v219, v215 offset:0x401f
    v_mfma_f32_32x32x16_bf16 v[64:79], v[208:211], v[200:203], v[64:79]
    s_waitcnt vmcnt(5)
    ds_read_b64_tr_b16 v[176:177], v237 offset:0
    ds_read_b64_tr_b16 v[178:179], v237 offset:2048
    ds_read_b64_tr_b16 v[180:181], v238 offset:0
    ds_read_b64_tr_b16 v[182:183], v238 offset:2048
    ds_read_b64_tr_b16 v[184:185], v239 offset:0
    ds_read_b64_tr_b16 v[186:187], v239 offset:2048
    ds_read_b64_tr_b16 v[188:189], v240 offset:0
    ds_read_b64_tr_b16 v[190:191], v240 offset:2048
    v_mfma_f32_32x32x16_bf16 v[152:167], v[208:211], v[204:207], v[152:167]
    s_waitcnt lgkmcnt(8)
    v_lshlrev_b32_sdwa v249, 9, v249 dst_sel:DWORD dst_unused:UNUSED_PAD src0_sel:DWORD src1_sel:WORD_1
    s_add_u32 s37, s37, 64
    s_sub_u32 s38, s38, 1
    s_cbranch_scc1 K2_OUT
K2_SF:
    s_mov_b32 m0, s42
    s_waitcnt lgkmcnt(0)
    v_add_u32_dpp v248, v249, v244 row_newbcast:0 row_mask:0xf bank_mask:0xf
    buffer_load_dwordx4 v248, s[8:11], s5 offen offset:0  lds
    v_add_u32_dpp v248, v249, v244 row_newbcast:1 row_mask:0xf bank_mask:0xf
    buffer_load_dwordx4 v248, s[8:11], s6 offen offset:1024  lds
    v_add_u32_dpp v248, v249, v244 row_newbcast:2 row_mask:0xf bank_mask:0xf
    buffer_load_dwordx4 v248, s[8:11], s7 offen offset:2048  lds
    v_add_u32_dpp v248, v249, v244 row_newbcast:3 row_mask:0xf bank_mask:0xf
    buffer_load_dwordx4 v248, s[8:11], 0 offen offset:3072  lds
    v_mfma_f32_32x32x16_bf16 v[40:55], v[212:215], v[200:203], v[40:55]
    s_waitcnt vmcnt(8)
    ds_read_u16_d16_hi v220, v241 offset:0
    ds_read_u16_d16_hi v221, v241 offset:16
    ds_read_u16_d16_hi v222, v241 offset:32
    ds_read_u16_d16_hi v223, v241 offset:48
    ds_read_u16_d16_hi v224, v241 offset:64
    ds_read_u16_d16_hi v225, v241 offset:80
    ds_read_u16_d16_hi v226, v241 offset:96
    ds_read_u16_d16_hi v227, v241 offset:112
    v_xor_b32 v216, v246, v216
    v_xor_b32 v217, v246, v217
    v_xor_b32 v218, v246, v218
    v_xor_b32 v219, v246, v219
    v_mfma_f32_32x32x16_bf16 v[128:143], v[212:215], v[204:207], v[128:143]
    s_waitcnt lgkmcnt(0)
    v_and_or_b32 v248, v236, s52, v245
    s_mov_b32 m0, s43
    s_mov_b64 exec, s[50:51]
    buffer_load_dwordx4 v248, s[12:15], 0 offen  lds
    s_mov_b64 exec, -1
    v_mul_f32_dpp v228, v232, v220 row_newbcast:0 row_mask:0xf bank_mask:0xf
    v_mul_f32_dpp v229, v232, v221 row_newbcast:1 row_mask:0xf bank_mask:0xf
    v_cvt_pk_bf16_f32 v208, v228, v229
    v_mfma_f32_32x32x16_bf16 v[72:87], v[216:219], v[192:195], v[72:87]
    v_mul_f32_dpp v230, v232, v222 row_newbcast:2 row_mask:0xf bank_mask:0xf
    v_mul_f32_dpp v231, v232, v223 row_newbcast:3 row_mask:0xf bank_mask:0xf
    v_cvt_pk_bf16_f32 v209, v230, v231
    v_mul_f32_dpp v228, v232, v224 row_newbcast:4 row_mask:0xf bank_mask:0xf
    v_mul_f32_dpp v229, v232, v225 row_newbcast:5 row_mask:0xf bank_mask:0xf
    v_cvt_pk_bf16_f32 v210, v228, v229
    v_mul_f32_dpp v230, v232, v226 row_newbcast:6 row_mask:0xf bank_mask:0xf
    v_mul_f32_dpp v231, v232, v227 row_newbcast:7 row_mask:0xf bank_mask:0xf
    v_cvt_pk_bf16_f32 v211, v230, v231
    s_sub_u32 s36, s36, 1
    v_mfma_f32_32x32x16_bf16 v[160:175], v[216:219], v[196:199], v[160:175]
    s_cbranch_scc0 K2_RF
K2_CON:
    s_setprio 0
    v_mbcnt_lo_u32_b32 v232, -1, 0
    v_mbcnt_hi_u32_b32 v232, -1, v232
    v_lshl_add_u32 v232, v232, 4, s59
    ds_read_b128 v[212:215], v232 offset:8192
    ds_read_b128 v[216:219], v232 offset:0
    ds_read_b128 v[228:231], v232 offset:9216
    s_waitcnt lgkmcnt(2)
    v_mul_f32 v16, v16, v212
    v_mul_f32 v24, v24, v212
    v_mul_f32 v8, v8, v212
    v_fmac_f32 v16, v17, v213
    v_fmac_f32 v24, v25, v213
    v_fmac_f32 v8, v9, v213
    v_fmac_f32 v16, v18, v214
    v_fmac_f32 v24, v26, v214
    v_fmac_f32 v8, v10, v214
    v_fmac_f32 v16, v19, v215
    v_fmac_f32 v24, v27, v215
    v_fmac_f32 v8, v11, v215
    ds_read_b128 v[212:215], v232 offset:1024
    s_waitcnt lgkmcnt(2)
    v_mul_f32 v0, v0, v216
    v_fmac_f32 v0, v1, v217
    v_fmac_f32 v0, v2, v218
    v_fmac_f32 v0, v3, v219
    ds_read_b128 v[216:219], v232 offset:10240
    s_waitcnt lgkmcnt(2)
    v_fmac_f32 v16, v20, v228
    v_fmac_f32 v24, v28, v228
    v_fmac_f32 v8, v12, v228
    v_fmac_f32 v16, v21, v229
    v_fmac_f32 v24, v29, v229
    v_fmac_f32 v8, v13, v229
    v_fmac_f32 v16, v22, v230
    v_fmac_f32 v24, v30, v230
    v_fmac_f32 v8, v14, v230
    v_fmac_f32 v16, v23, v231
    v_fmac_f32 v24, v31, v231
    v_fmac_f32 v8, v15, v231
    ds_read_b128 v[228:231], v232 offset:11264
    ds_read_b128 v[20:23], v232 offset:2048
    ds_read_b128 v[28:31], v232 offset:12288
    ds_read_b128 v[12:15], v232 offset:3072
    s_waitcnt lgkmcnt(3)
    v_fmac_f32 v0, v4, v212
    v_fmac_f32 v0, v5, v213
    v_fmac_f32 v0, v6, v214
    v_fmac_f32 v0, v7, v215
    ds_read_b128 v[212:215], v232 offset:13312
    ds_read_b128 v[4:7], v232 offset:14336
    v_mul_f32 v104, v104, v216
    v_mul_f32 v112, v112, v216
    v_mul_f32 v96, v96, v216
    v_fmac_f32 v104, v105, v217
    v_fmac_f32 v112, v113, v217
    v_fmac_f32 v96, v97, v217
    v_fmac_f32 v104, v106, v218
    v_fmac_f32 v112, v114, v218
    v_fmac_f32 v96, v98, v218
    v_fmac_f32 v104, v107, v219
    v_fmac_f32 v112, v115, v219
    v_fmac_f32 v96, v99, v219
    ds_read_b128 v[216:219], v232 offset:4096
    v_fmac_f32 v104, v108, v228
    v_fmac_f32 v112, v116, v228
    v_fmac_f32 v96, v100, v228
    v_fmac_f32 v104, v109, v229
    v_fmac_f32 v112, v117, v229
    v_fmac_f32 v96, v101, v229
    v_fmac_f32 v104, v110, v230
    v_fmac_f32 v112, v118, v230
    v_fmac_f32 v96, v102, v230
    v_fmac_f32 v104, v111, v231
    v_fmac_f32 v112, v119, v231
    v_fmac_f32 v96, v103, v231
    ds_read_b128 v[228:231], v232 offset:15360
    ds_read_b128 v[108:111], v232 offset:5120
    s_waitcnt lgkmcnt(5)
    v_mul_f32 v88, v88, v20
    v_fmac_f32 v88, v89, v21
    v_fmac_f32 v88, v90, v22
    v_fmac_f32 v88, v91, v23
    ds_read_b128 v[116:119], v232 offset:16384
    v_mul_f32 v32, v32, v28
    v_mul_f32 v56, v56, v28
    v_mul_f32 v64, v64, v28
    v_fmac_f32 v32, v33, v29
    v_fmac_f32 v56, v57, v29
    v_fmac_f32 v64, v65, v29
    v_fmac_f32 v32, v34, v30
    v_fmac_f32 v56, v58, v30
    v_fmac_f32 v64, v66, v30
    v_fmac_f32 v32, v35, v31
    v_fmac_f32 v56, v59, v31
    v_fmac_f32 v64, v67, v31
    ds_read_b128 v[100:103], v232 offset:17408
    v_fmac_f32 v88, v92, v12
    v_fmac_f32 v88, v93, v13
    v_fmac_f32 v88, v94, v14
    v_fmac_f32 v88, v95, v15
    s_cmp_eq_u32 s40, 4
    s_cbranch_scc1 VW_C
    s_waitcnt vmcnt(1)
VW_C:
    s_waitcnt vmcnt(5)
    ds_read_b64_tr_b16 v[192:193], v237 offset:4096
    ds_read_b64_tr_b16 v[194:195], v237 offset:6144
    ds_read_b64_tr_b16 v[196:197], v238 offset:4096
    ds_read_b64_tr_b16 v[198:199], v238 offset:6144
    ds_read_b64_tr_b16 v[200:201], v239 offset:4096
    ds_read_b64_tr_b16 v[202:203], v239 offset:6144
    ds_read_b64_tr_b16 v[204:205], v240 offset:4096
    ds_read_b64_tr_b16 v[206:207], v240 offset:6144
    ds_read_b128 v[20:23], v232 offset:6144
    s_waitcnt lgkmcnt(13)
    v_fmac_f32 v32, v36, v212
    v_fmac_f32 v56, v60, v212
    v_fmac_f32 v64, v68, v212
    v_fmac_f32 v32, v37, v213
    v_fmac_f32 v56, v61, v213
    v_fmac_f32 v64, v69, v213
    v_fmac_f32 v32, v38, v214
    v_fmac_f32 v56, v62, v214
    v_fmac_f32 v64, v70, v214
    v_fmac_f32 v32, v39, v215
    v_fmac_f32 v56, v63, v215
    v_fmac_f32 v64, v71, v215
    s_waitcnt lgkmcnt(1)
    s_mov_b32 m0, s4
    s_cmp_gt_u32 s40, 0
    s_cbranch_scc0 DX_C_10
    v_add_u32_dpp v248, v249, v244 row_newbcast:0 row_mask:0xf bank_mask:0xf
    buffer_load_dwordx4 v248, s[8:11], s94 offen offset:0  lds
DX_C_10:
    s_cmp_gt_u32 s40, 1
    s_cbranch_scc0 DX_C_11
    v_add_u32_dpp v248, v249, v244 row_newbcast:1 row_mask:0xf bank_mask:0xf
    buffer_load_dwordx4 v248, s[8:11], s95 offen offset:1024  lds
DX_C_11:
    s_cmp_gt_u32 s40, 2
    s_cbranch_scc0 DX_C_12
    v_add_u32_dpp v248, v249, v244 row_newbcast:2 row_mask:0xf bank_mask:0xf
    buffer_load_dwordx4 v248, s[8:11], s96 offen offset:2048  lds
DX_C_12:
    s_cmp_gt_u32 s40, 3
    s_cbranch_scc0 DX_C_13
    v_add_u32_dpp v248, v249, v244 row_newbcast:3 row_mask:0xf bank_mask:0xf
    buffer_load_dwordx4 v248, s[8:11], s97 offen offset:3072  lds
DX_C_13:
    ds_read_b128 v[28:31], v232 offset:18432
    v_mul_f32 v120, v120, v4
    v_mul_f32 v144, v144, v4
    v_mul_f32 v152, v152, v4
    v_fmac_f32 v120, v121, v5
    v_fmac_f32 v144, v145, v5
    v_fmac_f32 v152, v153, v5
    v_fmac_f32 v120, v122, v6
    v_fmac_f32 v144, v146, v6
    v_fmac_f32 v152, v154, v6
    v_fmac_f32 v120, v123, v7
    v_fmac_f32 v144, v147, v7
    v_fmac_f32 v152, v155, v7
    ds_read_b128 v[12:15], v232 offset:7168
    v_mul_f32 v72, v72, v216
    v_fmac_f32 v72, v73, v217
    v_fmac_f32 v72, v74, v218
    v_fmac_f32 v72, v75, v219
    ds_read_b128 v[92:95], v232 offset:19456
    v_fmac_f32 v120, v124, v228
    v_fmac_f32 v144, v148, v228
    v_fmac_f32 v152, v156, v228
    v_fmac_f32 v120, v125, v229
    v_fmac_f32 v144, v149, v229
    v_fmac_f32 v152, v157, v229
    v_fmac_f32 v120, v126, v230
    v_fmac_f32 v144, v150, v230
    v_fmac_f32 v152, v158, v230
    v_fmac_f32 v120, v127, v231
    v_fmac_f32 v144, v151, v231
    v_fmac_f32 v152, v159, v231
    v_fmac_f32 v72, v76, v108
    v_fmac_f32 v72, v77, v109
    v_fmac_f32 v72, v78, v110
    v_fmac_f32 v72, v79, v111
    v_mul_f32 v48, v48, v116
    v_mul_f32 v40, v40, v116
    v_mul_f32 v80, v80, v116
    v_fmac_f32 v48, v49, v117
    v_fmac_f32 v40, v41, v117
    v_fmac_f32 v80, v81, v117
    v_fmac_f32 v48, v50, v118
    v_fmac_f32 v40, v42, v118
    v_fmac_f32 v80, v82, v118
    v_fmac_f32 v48, v51, v119
    v_fmac_f32 v40, v43, v119
    v_fmac_f32 v80, v83, v119
    v_fmac_f32 v48, v52, v100
    v_fmac_f32 v40, v44, v100
    v_fmac_f32 v80, v84, v100
    v_fmac_f32 v48, v53, v101
    v_fmac_f32 v40, v45, v101
    v_fmac_f32 v80, v85, v101
    v_fmac_f32 v48, v54, v102
    v_fmac_f32 v40, v46, v102
    v_fmac_f32 v80, v86, v102
    v_fmac_f32 v48, v55, v103
    v_fmac_f32 v40, v47, v103
    v_fmac_f32 v80, v87, v103
    s_waitcnt lgkmcnt(1)
    v_mul_f32 v160, v160, v20
    v_fmac_f32 v160, v161, v21
    v_fmac_f32 v160, v162, v22
    v_fmac_f32 v160, v163, v23
    v_mul_f32 v136, v136, v28
    v_mul_f32 v128, v128, v28
    v_mul_f32 v168, v168, v28
    v_fmac_f32 v136, v137, v29
    v_fmac_f32 v128, v129, v29
    v_fmac_f32 v168, v169, v29
    v_fmac_f32 v136, v138, v30
    v_fmac_f32 v128, v130, v30
    v_fmac_f32 v168, v170, v30
    v_fmac_f32 v136, v139, v31
    v_fmac_f32 v128, v131, v31
    v_fmac_f32 v168, v171, v31
    v_fmac_f32 v160, v164, v12
    v_fmac_f32 v160, v165, v13
    v_fmac_f32 v160, v166, v14
    v_fmac_f32 v160, v167, v15
    s_waitcnt lgkmcnt(0)
    v_fmac_f32 v136, v140, v92
    v_fmac_f32 v128, v132, v92
    v_fmac_f32 v168, v172, v92
    v_fmac_f32 v136, v141, v93
    v_fmac_f32 v128, v133, v93
    v_fmac_f32 v168, v173, v93
    v_fmac_f32 v136, v142, v94
    v_fmac_f32 v128, v134, v94
    v_fmac_f32 v168, v174, v94
    v_fmac_f32 v136, v143, v95
    v_fmac_f32 v128, v135, v95
    v_fmac_f32 v168, v175, v95
    v_mbcnt_lo_u32_b32 v107, -1, 0
    v_mbcnt_hi_u32_b32 v107, -1, v107
    v_permlane32_swap_b32 v0, v88
    v_permlane32_swap_b32 v16, v104
    v_permlane32_swap_b32 v24, v112
    v_permlane32_swap_b32 v8, v96
    v_permlane32_swap_b32 v32, v120
    v_permlane32_swap_b32 v56, v144
    v_permlane32_swap_b32 v64, v152
    v_permlane32_swap_b32 v48, v136
    v_permlane32_swap_b32 v40, v128
    v_permlane32_swap_b32 v80, v168
    v_permlane32_swap_b32 v72, v160
    v_add_f32 v0, v0, v88
    v_add_f32 v16, v16, v104
    v_add_f32 v24, v24, v112
    v_add_f32 v8, v8, v96
    v_add_f32 v32, v32, v120
    v_add_f32 v56, v56, v144
    v_add_f32 v64, v64, v152
    v_add_f32 v48, v48, v136
    v_add_f32 v40, v40, v128
    v_add_f32 v80, v80, v168
    v_add_f32 v72, v72, v160
    s_cmp_eq_u32 s58, 0
    s_cbranch_scc1 AD_CN
    s_cmp_eq_u32 s58, 2
    s_cbranch_scc1 CON_ADD
    v_cvt_pk_bf16_f32 v250, v0, v72
    v_cvt_pk_bf16_f32 v251, v16, v32
    v_cvt_pk_bf16_f32 v252, v24, v56
    v_cvt_pk_bf16_f32 v253, v8, v64
    v_cvt_pk_bf16_f32 v254, v48, v40
    v_cvt_pk_bf16_f32 v255, v80, v80
    s_branch CON_END
CON_ADD:
    v_lshlrev_b32 v212, 16, v250
    v_and_b32 v213, 0xffff0000, v250
    v_add_f32 v0, v0, v212
    v_add_f32 v72, v72, v213
    v_lshlrev_b32 v212, 16, v251
    v_and_b32 v213, 0xffff0000, v251
    v_add_f32 v16, v16, v212
    v_add_f32 v32, v32, v213
    v_lshlrev_b32 v212, 16, v252
    v_and_b32 v213, 0xffff0000, v252
    v_add_f32 v24, v24, v212
    v_add_f32 v56, v56, v213
    v_lshlrev_b32 v212, 16, v253
    v_and_b32 v213, 0xffff0000, v253
    v_add_f32 v8, v8, v212
    v_add_f32 v64, v64, v213
    v_lshlrev_b32 v212, 16, v254
    v_and_b32 v213, 0xffff0000, v254
    v_add_f32 v48, v48, v212
    v_add_f32 v40, v40, v213
    v_lshlrev_b32 v212, 16, v255
    v_add_f32 v80, v80, v212
AD_CN:
    v_lshl_add_u32 v106, v107, 2, s35
    v_lshl_add_u32 v107, v107, 1, s35
    v_cvt_pk_bf16_f32 v213, v16, v32
    v_cvt_pk_bf16_f32 v214, v24, v56
    v_cvt_pk_bf16_f32 v215, -v8, v64
    v_cvt_pk_bf16_f32 v216, v48, -v40
    v_cvt_pk_bf16_f32 v217, -v80, -v80
    v_cvt_pk_bf16_f32 v212, v0, v72
    ds_write_b32 v106, v213 offset:256
    ds_write_b32 v106, v214 offset:512
    ds_write_b32 v106, v215 offset:768
    ds_write_b16 v107, v216 offset:1024
    ds_write_b16_d16_hi v107, v216 offset:1152
    ds_write_b16 v107, v217 offset:1280
    ds_write_b32 v106, v212
CON_END:
    v_mov_b64 v[64:65], 0
    v_mov_b64 v[66:67], 0
    v_mov_b64 v[68:69], 0
    v_mov_b64 v[70:71], 0
    v_mov_b64 v[152:153], 0
    v_mov_b64 v[154:155], 0
    v_mov_b64 v[156:157], 0
    v_mov_b64 v[158:159], 0
    s_setprio 1
    s_and_b32 s35, s48, 0xfff8
    s_lshl_b32 s35, s35, 1
    s_and_b32 s36, s48, 7
    s_bfe_u32 s58, s48, 0x20010
    s_lshr_b64 s[48:49], s[48:49], 20
    s_sub_u32 s53, s53, 20
    s_sub_u32 s36, s36, 1
    s_cbranch_scc0 K2_SEL
    s_branch K2_DONE
K2_FP:
    v_mfma_f32_32x32x16_bf16 v[0:15], v[208:211], v[176:179], 0
    v_mul_f32_dpp v228, v233, v220 row_newbcast:0 row_mask:0xf bank_mask:0xf
    v_mul_f32_dpp v229, v233, v221 row_newbcast:1 row_mask:0xf bank_mask:0xf
    v_cvt_pk_bf16_f32 v212, v228, v229
    v_mul_f32_dpp v230, v233, v222 row_newbcast:2 row_mask:0xf bank_mask:0xf
    v_mfma_f32_32x32x16_bf16 v[88:103], v[208:211], v[180:183], 0
    v_mul_f32_dpp v231, v233, v223 row_newbcast:3 row_mask:0xf bank_mask:0xf
    v_cvt_pk_bf16_f32 v213, v230, v231
    v_mul_f32_dpp v228, v233, v224 row_newbcast:4 row_mask:0xf bank_mask:0xf
    v_mul_f32_dpp v229, v233, v225 row_newbcast:5 row_mask:0xf bank_mask:0xf
    v_mfma_f32_32x32x16_bf16 v[32:47], v[208:211], v[184:187], 0
    v_cvt_pk_bf16_f32 v214, v228, v229
    v_mul_f32_dpp v230, v233, v226 row_newbcast:6 row_mask:0xf bank_mask:0xf
    v_mul_f32_dpp v231, v233, v227 row_newbcast:7 row_mask:0xf bank_mask:0xf
    v_cvt_pk_bf16_f32 v215, v230, v231
    v_mfma_f32_32x32x16_bf16 v[120:135], v[208:211], v[188:191], 0
    ds_swizzle_b32 v216, v208 offset:0x401f
    ds_swizzle_b32 v217, v209 offset:0x401f
    ds_swizzle_b32 v218, v210 offset:0x401f
    ds_swizzle_b32 v219, v211 offset:0x401f
    v_mfma_f32_32x32x16_bf16 v[16:31], v[212:215], v[176:179], 0
    v_cndmask_b32_sdwa v232, 1.0, v235, vcc dst_sel:WORD_1 dst_unused:UNUSED_PAD src0_sel:WORD_1 src1_sel:WORD_0
    v_cndmask_b32_sdwa v233, v234, v234, vcc dst_sel:WORD_1 dst_unused:UNUSED_PAD src0_sel:WORD_0 src1_sel:WORD_1
    v_mfma_f32_32x32x16_bf16 v[104:119], v[212:215], v[180:183], 0
    v_add_u32 v248, s37, v242
    ds_read2_b32 v[234:235], v248 offset0:0 offset1:112
    ds_read_b32 v236, v248 offset:896
    v_add_u32 v248, s37, v243
    ds_read_b32 v249, v248 offset:384
    v_mfma_f32_32x32x16_bf16 v[72:87], v[212:215], v[184:187], 0
    s_waitcnt lgkmcnt(3)
    v_xor_b32 v208, v246, v208
    v_xor_b32 v209, v246, v209
    v_xor_b32 v210, v246, v210
    v_xor_b32 v211, v246, v211
    v_mfma_f32_32x32x16_bf16 v[160:175], v[212:215], v[188:191], 0
    s_nop 1
    v_mfma_f32_32x32x16_bf16 v[48:63], v[216:219], v[192:195], 0
    s_nop 2
    v_mfma_f32_32x32x16_bf16 v[136:151], v[216:219], v[196:199], 0
    ds_swizzle_b32 v216, v212 offset:0x401f
    ds_swizzle_b32 v217, v213 offset:0x401f
    ds_swizzle_b32 v218, v214 offset:0x401f
    ds_swizzle_b32 v219, v215 offset:0x401f
    v_mfma_f32_32x32x16_bf16 v[64:79], v[208:211], v[200:203], v[64:79]
    s_waitcnt vmcnt(0)
    ds_read_b64_tr_b16 v[176:177], v237 offset:0
    ds_read_b64_tr_b16 v[178:179], v237 offset:2048
    ds_read_b64_tr_b16 v[180:181], v238 offset:0
    ds_read_b64_tr_b16 v[182:183], v238 offset:2048
    ds_read_b64_tr_b16 v[184:185], v239 offset:0
    ds_read_b64_tr_b16 v[186:187], v239 offset:2048
    ds_read_b64_tr_b16 v[188:189], v240 offset:0
    ds_read_b64_tr_b16 v[190:191], v240 offset:2048
    v_mfma_f32_32x32x16_bf16 v[152:167], v[208:211], v[204:207], v[152:167]
    s_waitcnt lgkmcnt(8)
    v_lshlrev_b32_sdwa v249, 9, v249 dst_sel:DWORD dst_unused:UNUSED_PAD src0_sel:DWORD src1_sel:WORD_1
    s_mov_b32 s40, 4
    s_add_u32 s37, s37, 64
    s_sub_u32 s38, s38, 1
    s_cbranch_scc1 K2_OUT
    s_branch K2_SF
K2_OUT:
s_mov_b32 s40, s39
    s_cmp_eq_u32 s54, 1
    s_cbranch_scc1 FB_O
    s_cmp_eq_u32 s54, 2
    s_cbranch_scc1 FC_O
    s_mov_b32 s55, 0
    s_mov_b64 exec, 1
    ds_add_rtn_u32 v228, v245, v243 offset:0
    s_mov_b64 exec, -1
    s_waitcnt lgkmcnt(0)
    v_readfirstlane_b32 s44, v228
    s_lshr_b32 s44, s44, 5
    s_min_u32 s44, s44, 62
    s_add_u32 s45, s44, 1
    s_nop 0
    v_readlane_b32 s56, v247, s44
    v_readlane_b32 s57, v247, s45
    s_mov_b32 s44, s56
    s_and_b32 s45, s57, 7
    s_cbranch_scc0 FN_O
    s_mov_b32 s54, 1
    s_bfe_u32 s45, s56, 0x20001
    s_cbranch_scc0 FN_O
    s_mov_b32 s55, 2
    s_and_b32 s46, s56, 0xfff8
    s_lshl_b32 s37, s46, 1
    s_sub_u32 s38, s45, 1
    s_mov_b32 s39, 4
    s_or_b32 s46, s46, s45
    s_bitset1_b32 s46, 16
    s_branch FP_O
FC_O:
    s_mov_b32 s54, 0
    s_bfe_u32 s45, s56, 0x20001
    s_and_b32 s46, s56, 0xfff8
    s_lshl_b32 s44, s45, 5
    s_add_u32 s44, s44, s46
    s_lshl_b32 s37, s44, 1
    s_and_b32 s46, s56, 0xffff
    s_sub_u32 s46, s46, s45
    s_lshr_b32 s44, s56, 20
    s_sub_u32 s38, s44, s45
    s_bfe_u32 s39, s56, 0x30010
    s_bitset1_b32 s46, 17
    s_branch FP_O
FB_O:
    s_mov_b32 s54, s55
    s_mov_b32 s44, s57
FN_O:
    s_and_b32 s37, s44, 0xfff8
    s_lshl_b32 s37, s37, 1
    s_bfe_u32 s39, s44, 0x30010
    s_lshr_b32 s38, s44, 20
    s_and_b32 s46, s44, 0xffff
FP_O:
    s_mov_b32 s47, 0
    s_lshl_b64 s[46:47], s[46:47], s53
    s_or_b64 s[48:49], s[48:49], s[46:47]
    s_add_u32 s53, s53, 20
    s_cmp_eq_u32 s40, 4
    s_cbranch_scc1 K2_SF
    s_mov_b32 m0, s42
    s_waitcnt lgkmcnt(0)
    s_cmp_gt_u32 s40, 0
    s_cbranch_scc0 DX_S_00
    v_add_u32_dpp v248, v249, v244 row_newbcast:0 row_mask:0xf bank_mask:0xf
    buffer_load_dwordx4 v248, s[8:11], s5 offen offset:0  lds
DX_S_00:
    s_cmp_gt_u32 s40, 1
    s_cbranch_scc0 DX_S_01
    v_add_u32_dpp v248, v249, v244 row_newbcast:1 row_mask:0xf bank_mask:0xf
    buffer_load_dwordx4 v248, s[8:11], s6 offen offset:1024  lds
DX_S_01:
    s_cmp_gt_u32 s40, 2
    s_cbranch_scc0 DX_S_02
    v_add_u32_dpp v248, v249, v244 row_newbcast:2 row_mask:0xf bank_mask:0xf
    buffer_load_dwordx4 v248, s[8:11], s7 offen offset:2048  lds
DX_S_02:
    s_cmp_gt_u32 s40, 3
    s_cbranch_scc0 DX_S_03
    v_add_u32_dpp v248, v249, v244 row_newbcast:3 row_mask:0xf bank_mask:0xf
    buffer_load_dwordx4 v248, s[8:11], 0 offen offset:3072  lds
DX_S_03:
    v_mfma_f32_32x32x16_bf16 v[40:55], v[212:215], v[200:203], v[40:55]
    s_waitcnt vmcnt(4)
    ds_read_u16_d16_hi v220, v241 offset:0
    ds_read_u16_d16_hi v221, v241 offset:16
    ds_read_u16_d16_hi v222, v241 offset:32
    ds_read_u16_d16_hi v223, v241 offset:48
    ds_read_u16_d16_hi v224, v241 offset:64
    ds_read_u16_d16_hi v225, v241 offset:80
    ds_read_u16_d16_hi v226, v241 offset:96
    ds_read_u16_d16_hi v227, v241 offset:112
    v_xor_b32 v216, v246, v216
    v_xor_b32 v217, v246, v217
    v_xor_b32 v218, v246, v218
    v_xor_b32 v219, v246, v219
    v_mfma_f32_32x32x16_bf16 v[128:143], v[212:215], v[204:207], v[128:143]
    s_waitcnt lgkmcnt(0)
    v_and_or_b32 v248, v236, s52, v245
    s_mov_b32 m0, s43
    s_mov_b64 exec, s[50:51]
    buffer_load_dwordx4 v248, s[12:15], 0 offen  lds
    s_mov_b64 exec, -1
    v_mul_f32_dpp v228, v232, v220 row_newbcast:0 row_mask:0xf bank_mask:0xf
    v_mul_f32_dpp v229, v232, v221 row_newbcast:1 row_mask:0xf bank_mask:0xf
    v_cvt_pk_bf16_f32 v208, v228, v229
    v_mfma_f32_32x32x16_bf16 v[72:87], v[216:219], v[192:195], v[72:87]
    v_mul_f32_dpp v230, v232, v222 row_newbcast:2 row_mask:0xf bank_mask:0xf
    v_mul_f32_dpp v231, v232, v223 row_newbcast:3 row_mask:0xf bank_mask:0xf
    v_cvt_pk_bf16_f32 v209, v230, v231
    v_mul_f32_dpp v228, v232, v224 row_newbcast:4 row_mask:0xf bank_mask:0xf
    v_mul_f32_dpp v229, v232, v225 row_newbcast:5 row_mask:0xf bank_mask:0xf
    v_cvt_pk_bf16_f32 v210, v228, v229
    v_mul_f32_dpp v230, v232, v226 row_newbcast:6 row_mask:0xf bank_mask:0xf
    v_mul_f32_dpp v231, v232, v227 row_newbcast:7 row_mask:0xf bank_mask:0xf
    v_cvt_pk_bf16_f32 v211, v230, v231
    s_sub_u32 s36, s36, 1
    v_mfma_f32_32x32x16_bf16 v[160:175], v[216:219], v[196:199], v[160:175]
    s_cbranch_scc1 K2_CON
    v_mfma_f32_32x32x16_bf16 v[0:15], v[208:211], v[176:179], v[0:15]
    v_mul_f32_dpp v228, v233, v220 row_newbcast:0 row_mask:0xf bank_mask:0xf
    v_mul_f32_dpp v229, v233, v221 row_newbcast:1 row_mask:0xf bank_mask:0xf
    v_cvt_pk_bf16_f32 v212, v228, v229
    v_mul_f32_dpp v230, v233, v222 row_newbcast:2 row_mask:0xf bank_mask:0xf
    v_mfma_f32_32x32x16_bf16 v[88:103], v[208:211], v[180:183], v[88:103]
    v_mul_f32_dpp v231, v233, v223 row_newbcast:3 row_mask:0xf bank_mask:0xf
    v_cvt_pk_bf16_f32 v213, v230, v231
    v_mul_f32_dpp v228, v233, v224 row_newbcast:4 row_mask:0xf bank_mask:0xf
    v_mul_f32_dpp v229, v233, v225 row_newbcast:5 row_mask:0xf bank_mask:0xf
    v_mfma_f32_32x32x16_bf16 v[32:47], v[208:211], v[184:187], v[32:47]
    v_cvt_pk_bf16_f32 v214, v228, v229
    v_mul_f32_dpp v230, v233, v226 row_newbcast:6 row_mask:0xf bank_mask:0xf
    v_mul_f32_dpp v231, v233, v227 row_newbcast:7 row_mask:0xf bank_mask:0xf
    v_cvt_pk_bf16_f32 v215, v230, v231
    v_mfma_f32_32x32x16_bf16 v[120:135], v[208:211], v[188:191], v[120:135]
    s_waitcnt vmcnt(1)
    ds_read_b64_tr_b16 v[192:193], v237 offset:4096
    ds_read_b64_tr_b16 v[194:195], v237 offset:6144
    ds_read_b64_tr_b16 v[196:197], v238 offset:4096
    ds_read_b64_tr_b16 v[198:199], v238 offset:6144
    ds_read_b64_tr_b16 v[200:201], v239 offset:4096
    ds_read_b64_tr_b16 v[202:203], v239 offset:6144
    ds_read_b64_tr_b16 v[204:205], v240 offset:4096
    ds_read_b64_tr_b16 v[206:207], v240 offset:6144
    v_mfma_f32_32x32x16_bf16 v[16:31], v[212:215], v[176:179], v[16:31]
    ds_swizzle_b32 v216, v208 offset:0x401f
    ds_swizzle_b32 v217, v209 offset:0x401f
    ds_swizzle_b32 v218, v210 offset:0x401f
    ds_swizzle_b32 v219, v211 offset:0x401f
    s_mov_b32 m0, s4
    v_mfma_f32_32x32x16_bf16 v[104:119], v[212:215], v[180:183], v[104:119]
    s_waitcnt lgkmcnt(4)
    s_cmp_gt_u32 s40, 0
    s_cbranch_scc0 DX_R_10
    v_add_u32_dpp v248, v249, v244 row_newbcast:0 row_mask:0xf bank_mask:0xf
    buffer_load_dwordx4 v248, s[8:11], s94 offen offset:0  lds
DX_R_10:
    s_cmp_gt_u32 s40, 1
    s_cbranch_scc0 DX_R_11
    v_add_u32_dpp v248, v249, v244 row_newbcast:1 row_mask:0xf bank_mask:0xf
    buffer_load_dwordx4 v248, s[8:11], s95 offen offset:1024  lds
DX_R_11:
    s_cmp_gt_u32 s40, 2
    s_cbranch_scc0 DX_R_12
    v_add_u32_dpp v248, v249, v244 row_newbcast:2 row_mask:0xf bank_mask:0xf
    buffer_load_dwordx4 v248, s[8:11], s96 offen offset:2048  lds
DX_R_12:
    s_cmp_gt_u32 s40, 3
    s_cbranch_scc0 DX_R_13
    v_add_u32_dpp v248, v249, v244 row_newbcast:3 row_mask:0xf bank_mask:0xf
    buffer_load_dwordx4 v248, s[8:11], s97 offen offset:3072  lds
DX_R_13:
    v_cndmask_b32_sdwa v232, 1.0, v235, vcc dst_sel:WORD_1 dst_unused:UNUSED_PAD src0_sel:WORD_1 src1_sel:WORD_0
    v_cndmask_b32_sdwa v233, v234, v234, vcc dst_sel:WORD_1 dst_unused:UNUSED_PAD src0_sel:WORD_0 src1_sel:WORD_1
    v_mfma_f32_32x32x16_bf16 v[72:87], v[212:215], v[184:187], v[72:87]
    v_add_u32 v248, s37, v242
    ds_read2_b32 v[234:235], v248 offset0:0 offset1:112
    ds_read_b32 v236, v248 offset:896
    v_add_u32 v248, s37, v243
    ds_read_b32 v249, v248 offset:384
    v_mfma_f32_32x32x16_bf16 v[160:175], v[212:215], v[188:191], v[160:175]
    s_waitcnt lgkmcnt(3)
    v_xor_b32 v208, v246, v208
    v_xor_b32 v209, v246, v209
    v_xor_b32 v210, v246, v210
    v_xor_b32 v211, v246, v211
    v_mfma_f32_32x32x16_bf16 v[48:63], v[216:219], v[192:195], v[48:63]
    v_mfma_f32_32x32x16_bf16 v[136:151], v[216:219], v[196:199], v[136:151]
    ds_swizzle_b32 v216, v212 offset:0x401f
    ds_swizzle_b32 v217, v213 offset:0x401f
    ds_swizzle_b32 v218, v214 offset:0x401f
    ds_swizzle_b32 v219, v215 offset:0x401f
    v_mfma_f32_32x32x16_bf16 v[64:79], v[208:211], v[200:203], v[64:79]
    s_waitcnt vmcnt(0)
    ds_read_b64_tr_b16 v[176:177], v237 offset:0
    ds_read_b64_tr_b16 v[178:179], v237 offset:2048
    ds_read_b64_tr_b16 v[180:181], v238 offset:0
    ds_read_b64_tr_b16 v[182:183], v238 offset:2048
    ds_read_b64_tr_b16 v[184:185], v239 offset:0
    ds_read_b64_tr_b16 v[186:187], v239 offset:2048
    ds_read_b64_tr_b16 v[188:189], v240 offset:0
    ds_read_b64_tr_b16 v[190:191], v240 offset:2048
    v_mfma_f32_32x32x16_bf16 v[152:167], v[208:211], v[204:207], v[152:167]
    s_waitcnt lgkmcnt(8)
    v_lshlrev_b32_sdwa v249, 9, v249 dst_sel:DWORD dst_unused:UNUSED_PAD src0_sel:DWORD src1_sel:WORD_1
    s_mov_b32 s40, 4
    s_add_u32 s37, s37, 64
    s_sub_u32 s38, s38, 1
    s_cbranch_scc1 K2_OUT
    s_branch K2_SF
K2_DONE:
    v_mbcnt_lo_u32_b32 v175, -1, 0
    v_mbcnt_hi_u32_b32 v175, -1, v175
    s_mov_b64 exec, 1
    ds_add_rtn_u32 v228, v245, v243 offset:4
    s_mov_b64 exec, -1
    s_waitcnt vmcnt(0) lgkmcnt(0)
    v_readfirstlane_b32 s88, v228
    v_lshlrev_b32 v228, 4, v175
    v_and_b32 v229, 31, v175
    v_lshrrev_b32 v230, 5, v175
    s_lshr_b32 s88, s88, 6
    s_and_b32 s44, s88, 1
    s_lshl_b32 s44, s44, 5
    v_add_u32 v229, s44, v229
    v_mul_u32_u24 v231, 1424, v229
    v_lshl_add_u32 v231, v230, 4, v231
    v_lshlrev_b32 v248, 9, v229
    v_lshl_add_u32 v248, v230, 5, v248
    s_cmp_ge_u32 s88, 4
    s_cbranch_scc1 K2_NOFR
    s_lshr_b32 s44, s88, 1
    s_mul_i32 s44, s44, 20480
    s_add_u32 s44, s44, 26397696
    buffer_load_dwordx4 v[0:3], v228, s[16:19], s44 offen offset:0 sc1
    buffer_load_dwordx4 v[4:7], v228, s[16:19], s44 offen offset:1024 sc1
    buffer_load_dwordx4 v[8:11], v228, s[16:19], s44 offen offset:2048 sc1
    buffer_load_dwordx4 v[12:15], v228, s[16:19], s44 offen offset:3072 sc1
    s_add_u32 s44, s44, 4096
    buffer_load_dwordx4 v[16:19], v228, s[16:19], s44 offen offset:0 sc1
    buffer_load_dwordx4 v[20:23], v228, s[16:19], s44 offen offset:1024 sc1
    buffer_load_dwordx4 v[24:27], v228, s[16:19], s44 offen offset:2048 sc1
    buffer_load_dwordx4 v[28:31], v228, s[16:19], s44 offen offset:3072 sc1
    s_add_u32 s44, s44, 4096
    buffer_load_dwordx4 v[32:35], v228, s[16:19], s44 offen offset:0 sc1
    buffer_load_dwordx4 v[36:39], v228, s[16:19], s44 offen offset:1024 sc1
    buffer_load_dwordx4 v[40:43], v228, s[16:19], s44 offen offset:2048 sc1
    buffer_load_dwordx4 v[44:47], v228, s[16:19], s44 offen offset:3072 sc1
    s_add_u32 s44, s44, 4096
    buffer_load_dwordx4 v[48:51], v228, s[16:19], s44 offen offset:0 sc1
    buffer_load_dwordx4 v[52:55], v228, s[16:19], s44 offen offset:1024 sc1
    buffer_load_dwordx4 v[56:59], v228, s[16:19], s44 offen offset:2048 sc1
    buffer_load_dwordx4 v[60:63], v228, s[16:19], s44 offen offset:3072 sc1
    s_add_u32 s44, s44, 4096
    buffer_load_dwordx4 v[64:67], v228, s[16:19], s44 offen offset:0 sc1
    buffer_load_dwordx4 v[68:71], v228, s[16:19], s44 offen offset:1024 sc1
    buffer_load_dwordx4 v[72:75], v228, s[16:19], s44 offen offset:2048 sc1
    buffer_load_dwordx4 v[76:79], v228, s[16:19], s44 offen offset:3072 sc1
K2_NOFR:
    s_mul_i32 s44, s24, 25088
    s_lshr_b32 s45, s88, 1
    s_lshl_b32 s45, s45, 6
    s_add_u32 s46, s44, s45
    v_cmp_gt_u32 vcc, s25, v229
    s_add_u32 s45, s45, 91232
    v_mul_u32_u24 v249, 528, v229
    v_lshl_add_u32 v249, v230, 5, v249
    v_add_u32 v249, s45, v249
    s_barrier
    s_and_b32 s45, s30, s31
    s_cbranch_scc0 K2_SLOWQ
    s_cmp_ge_u32 s88, 4
    s_cbranch_scc1 K2_COPY
K2_SLOWQ:
    s_cmp_ge_u32 s88, 4
    s_cbranch_scc1 K2_NEXTWIN
    s_and_b32 s44, s30, s31
    s_cbranch_scc0 K2_SLOWEP
    ds_read_b128 v[144:147], v231 offset:16
    ds_read_b128 v[148:151], v231 offset:48
    ds_read_b128 v[152:155], v231 offset:80
    ds_read_b128 v[156:159], v231 offset:112
    ds_read_b128 v[160:163], v231 offset:144
    ds_read_b128 v[164:167], v231 offset:176
    ds_read_b128 v[168:171], v231 offset:208
    s_waitcnt vmcnt(0)
    ds_read_b128 v[172:175], v231 offset:240
    s_waitcnt lgkmcnt(7)
    v_mfma_f32_32x32x16_bf16 v[80:95], v[0:3], v[144:147], 0
    ds_read_b128 v[144:147], v231 offset:272
    s_waitcnt lgkmcnt(7)
    v_mfma_f32_32x32x16_bf16 v[80:95], v[4:7], v[148:151], v[80:95]
    ds_read_b128 v[148:151], v231 offset:304
    s_waitcnt lgkmcnt(7)
    v_mfma_f32_32x32x16_bf16 v[80:95], v[8:11], v[152:155], v[80:95]
    ds_read_b128 v[152:155], v231 offset:336
    s_waitcnt lgkmcnt(7)
    v_mfma_f32_32x32x16_bf16 v[80:95], v[12:15], v[156:159], v[80:95]
    ds_read_b128 v[156:159], v231 offset:368
    s_waitcnt lgkmcnt(7)
    v_mfma_f32_32x32x16_bf16 v[80:95], v[16:19], v[160:163], v[80:95]
    ds_read_b128 v[160:163], v231 offset:400
    s_waitcnt lgkmcnt(7)
    v_mfma_f32_32x32x16_bf16 v[80:95], v[20:23], v[164:167], v[80:95]
    ds_read_b128 v[164:167], v231 offset:432
    s_waitcnt lgkmcnt(7)
    v_mfma_f32_32x32x16_bf16 v[80:95], v[24:27], v[168:171], v[80:95]
    ds_read_b128 v[168:171], v231 offset:464
    s_waitcnt lgkmcnt(7)
    v_mfma_f32_32x32x16_bf16 v[80:95], v[28:31], v[172:175], v[80:95]
    ds_read_b128 v[172:175], v231 offset:496
    s_waitcnt lgkmcnt(7)
    v_mfma_f32_32x32x16_bf16 v[96:111], v[32:35], v[144:147], 0
    ds_read_b128 v[144:147], v231 offset:1040
    s_waitcnt lgkmcnt(7)
    v_mfma_f32_32x32x16_bf16 v[96:111], v[36:39], v[148:151], v[96:111]
    ds_read_b128 v[148:151], v231 offset:1072
    s_waitcnt lgkmcnt(7)
    v_mfma_f32_32x32x16_bf16 v[96:111], v[40:43], v[152:155], v[96:111]
    ds_read_b128 v[152:155], v231 offset:1104
    s_waitcnt lgkmcnt(7)
    v_mfma_f32_32x32x16_bf16 v[96:111], v[44:47], v[156:159], v[96:111]
    v_cvt_pk_bf16_f32 v192, v80, v81
    v_cvt_pk_bf16_f32 v193, v82, v83
    v_cvt_pk_bf16_f32 v194, v84, v85
    v_cvt_pk_bf16_f32 v195, v86, v87
    ds_read_b128 v[156:159], v231 offset:1136
    s_waitcnt lgkmcnt(7)
    v_mfma_f32_32x32x16_bf16 v[96:111], v[48:51], v[160:163], v[96:111]
    v_cvt_pk_bf16_f32 v196, v88, v89
    v_cvt_pk_bf16_f32 v197, v90, v91
    v_cvt_pk_bf16_f32 v198, v92, v93
    v_cvt_pk_bf16_f32 v199, v94, v95
    ds_read_b128 v[160:163], v231 offset:528
    s_waitcnt lgkmcnt(7)
    v_mfma_f32_32x32x16_bf16 v[96:111], v[52:55], v[164:167], v[96:111]
    ds_write_b128 v249, v[192:195] offset:0
    ds_write_b128 v249, v[196:199] offset:16
    ds_read_b128 v[164:167], v231 offset:560
    s_waitcnt lgkmcnt(9)
    v_mfma_f32_32x32x16_bf16 v[96:111], v[56:59], v[168:171], v[96:111]
    v_mul_f32 v176, 0xbfb8aa3b, v80
    v_mul_f32 v177, 0xbfb8aa3b, v81
    v_mul_f32 v178, 0xbfb8aa3b, v82
    v_mul_f32 v179, 0xbfb8aa3b, v83
    v_mul_f32 v180, 0xbfb8aa3b, v84
    ds_read_b128 v[168:171], v231 offset:592
    s_waitcnt lgkmcnt(9)
    v_mfma_f32_32x32x16_bf16 v[96:111], v[60:63], v[172:175], v[96:111]
    v_mul_f32 v181, 0xbfb8aa3b, v85
    v_mul_f32 v182, 0xbfb8aa3b, v86
    v_mul_f32 v183, 0xbfb8aa3b, v87
    v_mul_f32 v184, 0xbfb8aa3b, v88
    v_mul_f32 v185, 0xbfb8aa3b, v89
    ds_read_b128 v[172:175], v231 offset:624
    s_waitcnt lgkmcnt(9)
    v_mfma_f32_32x32x16_bf16 v[96:111], v[64:67], v[144:147], v[96:111]
    v_mul_f32 v186, 0xbfb8aa3b, v90
    v_mul_f32 v187, 0xbfb8aa3b, v91
    v_mul_f32 v188, 0xbfb8aa3b, v92
    v_mul_f32 v189, 0xbfb8aa3b, v93
    v_mul_f32 v190, 0xbfb8aa3b, v94
    v_mul_f32 v191, 0xbfb8aa3b, v95
    ds_read_b128 v[144:147], v231 offset:656
    s_waitcnt lgkmcnt(9)
    v_mfma_f32_32x32x16_bf16 v[96:111], v[68:71], v[148:151], v[96:111]
    v_exp_f32 v176, v176
    v_exp_f32 v177, v177
    v_exp_f32 v178, v178
    v_exp_f32 v179, v179
    v_exp_f32 v180, v180
    ds_read_b128 v[148:151], v231 offset:688
    s_waitcnt lgkmcnt(9)
    v_mfma_f32_32x32x16_bf16 v[96:111], v[72:75], v[152:155], v[96:111]
    v_exp_f32 v181, v181
    v_exp_f32 v182, v182
    v_exp_f32 v183, v183
    v_exp_f32 v184, v184
    v_exp_f32 v185, v185
    ds_read_b128 v[152:155], v231 offset:720
    s_waitcnt lgkmcnt(9)
    v_mfma_f32_32x32x16_bf16 v[96:111], v[76:79], v[156:159], v[96:111]
    v_exp_f32 v186, v186
    v_exp_f32 v187, v187
    v_exp_f32 v188, v188
    v_exp_f32 v189, v189
    v_exp_f32 v190, v190
    v_exp_f32 v191, v191
    ds_read_b128 v[156:159], v231 offset:752
    s_waitcnt lgkmcnt(9)
    v_mfma_f32_32x32x16_bf16 v[112:127], v[32:35], v[160:163], 0
    v_add_f32 v176, 1.0, v176
    v_add_f32 v177, 1.0, v177
    v_add_f32 v178, 1.0, v178
    v_add_f32 v179, 1.0, v179
    v_add_f32 v180, 1.0, v180
    ds_read_b128 v[160:163], v231 offset:1168
    s_waitcnt lgkmcnt(7)
    v_mfma_f32_32x32x16_bf16 v[112:127], v[36:39], v[164:167], v[112:127]
    v_add_f32 v181, 1.0, v181
    v_add_f32 v182, 1.0, v182
    v_add_f32 v183, 1.0, v183
    v_add_f32 v184, 1.0, v184
    v_add_f32 v185, 1.0, v185
    ds_read_b128 v[164:167], v231 offset:1200
    s_waitcnt lgkmcnt(7)
    v_mfma_f32_32x32x16_bf16 v[112:127], v[40:43], v[168:171], v[112:127]
    v_add_f32 v186, 1.0, v186
    v_add_f32 v187, 1.0, v187
    v_add_f32 v188, 1.0, v188
    v_add_f32 v189, 1.0, v189
    v_add_f32 v190, 1.0, v190
    v_add_f32 v191, 1.0, v191
    ds_read_b128 v[168:171], v231 offset:1232
    s_waitcnt lgkmcnt(7)
    v_mfma_f32_32x32x16_bf16 v[112:127], v[44:47], v[172:175], v[112:127]
    v_rcp_f32 v176, v176
    v_rcp_f32 v177, v177
    v_rcp_f32 v178, v178
    v_rcp_f32 v179, v179
    v_rcp_f32 v180, v180
    ds_read_b128 v[172:175], v231 offset:1264
    s_waitcnt lgkmcnt(7)
    v_mfma_f32_32x32x16_bf16 v[112:127], v[48:51], v[144:147], v[112:127]
    v_rcp_f32 v181, v181
    v_rcp_f32 v182, v182
    v_rcp_f32 v183, v183
    v_rcp_f32 v184, v184
    v_rcp_f32 v185, v185
    ds_read_b128 v[144:147], v231 offset:784
    s_waitcnt lgkmcnt(7)
    v_mfma_f32_32x32x16_bf16 v[112:127], v[52:55], v[148:151], v[112:127]
    v_rcp_f32 v186, v186
    v_rcp_f32 v187, v187
    v_rcp_f32 v188, v188
    v_rcp_f32 v189, v189
    v_rcp_f32 v190, v190
    v_rcp_f32 v191, v191
    ds_read_b128 v[148:151], v231 offset:816
    s_waitcnt lgkmcnt(7)
    v_mfma_f32_32x32x16_bf16 v[112:127], v[56:59], v[152:155], v[112:127]
    v_mul_f32 v96, v96, v176
    v_mul_f32 v97, v97, v177
    v_mul_f32 v98, v98, v178
    v_mul_f32 v99, v99, v179
    ds_read_b128 v[152:155], v231 offset:848
    s_waitcnt lgkmcnt(7)
    v_mfma_f32_32x32x16_bf16 v[112:127], v[60:63], v[156:159], v[112:127]
    v_mul_f32 v100, v100, v180
    v_mul_f32 v101, v101, v181
    v_mul_f32 v102, v102, v182
    v_mul_f32 v103, v103, v183
    ds_read_b128 v[156:159], v231 offset:880
    s_waitcnt lgkmcnt(7)
    v_mfma_f32_32x32x16_bf16 v[112:127], v[64:67], v[160:163], v[112:127]
    v_mul_f32 v104, v104, v184
    v_mul_f32 v105, v105, v185
    v_mul_f32 v106, v106, v186
    v_mul_f32 v107, v107, v187
    ds_read_b128 v[160:163], v231 offset:912
    s_waitcnt lgkmcnt(7)
    v_mfma_f32_32x32x16_bf16 v[112:127], v[68:71], v[164:167], v[112:127]
    v_mul_f32 v108, v108, v188
    v_mul_f32 v109, v109, v189
    v_mul_f32 v110, v110, v190
    v_mul_f32 v111, v111, v191
    ds_read_b128 v[164:167], v231 offset:944
    s_waitcnt lgkmcnt(7)
    v_mfma_f32_32x32x16_bf16 v[112:127], v[72:75], v[168:171], v[112:127]
    v_cvt_pk_bf16_f32 v200, v96, v97
    v_cvt_pk_bf16_f32 v201, v98, v99
    v_cvt_pk_bf16_f32 v202, v100, v101
    v_cvt_pk_bf16_f32 v203, v102, v103
    ds_read_b128 v[168:171], v231 offset:976
    s_waitcnt lgkmcnt(7)
    v_mfma_f32_32x32x16_bf16 v[112:127], v[76:79], v[172:175], v[112:127]
    v_cvt_pk_bf16_f32 v204, v104, v105
    v_cvt_pk_bf16_f32 v205, v106, v107
    v_cvt_pk_bf16_f32 v206, v108, v109
    v_cvt_pk_bf16_f32 v207, v110, v111
    ds_read_b128 v[172:175], v231 offset:1008
    s_waitcnt lgkmcnt(7)
    v_mfma_f32_32x32x16_bf16 v[128:143], v[32:35], v[144:147], 0
    ds_write_b128 v249, v[200:203] offset:128
    ds_write_b128 v249, v[204:207] offset:144
    ds_read_b128 v[144:147], v231 offset:1296
    s_waitcnt lgkmcnt(9)
    v_mfma_f32_32x32x16_bf16 v[128:143], v[36:39], v[148:151], v[128:143]
    ds_read_b128 v[148:151], v231 offset:1328
    s_waitcnt lgkmcnt(9)
    v_mfma_f32_32x32x16_bf16 v[128:143], v[40:43], v[152:155], v[128:143]
    ds_read_b128 v[152:155], v231 offset:1360
    s_waitcnt lgkmcnt(9)
    v_mfma_f32_32x32x16_bf16 v[128:143], v[44:47], v[156:159], v[128:143]
    ds_read_b128 v[156:159], v231 offset:1392
    s_waitcnt lgkmcnt(9)
    v_mfma_f32_32x32x16_bf16 v[128:143], v[48:51], v[160:163], v[128:143]
    v_mul_f32 v112, v112, v176
    v_mul_f32 v113, v113, v177
    v_mul_f32 v114, v114, v178
    v_mul_f32 v115, v115, v179
    s_waitcnt lgkmcnt(8)
    v_mfma_f32_32x32x16_bf16 v[128:143], v[52:55], v[164:167], v[128:143]
    v_mul_f32 v116, v116, v180
    v_mul_f32 v117, v117, v181
    v_mul_f32 v118, v118, v182
    v_mul_f32 v119, v119, v183
    s_waitcnt lgkmcnt(7)
    v_mfma_f32_32x32x16_bf16 v[128:143], v[56:59], v[168:171], v[128:143]
    v_mul_f32 v120, v120, v184
    v_mul_f32 v121, v121, v185
    v_mul_f32 v122, v122, v186
    v_mul_f32 v123, v123, v187
    s_waitcnt lgkmcnt(6)
    v_mfma_f32_32x32x16_bf16 v[128:143], v[60:63], v[172:175], v[128:143]
    v_mul_f32 v124, v124, v188
    v_mul_f32 v125, v125, v189
    v_mul_f32 v126, v126, v190
    v_mul_f32 v127, v127, v191
    s_waitcnt lgkmcnt(3)
    v_mfma_f32_32x32x16_bf16 v[128:143], v[64:67], v[144:147], v[128:143]
    v_cvt_pk_bf16_f32 v192, v112, v113
    v_cvt_pk_bf16_f32 v193, v114, v115
    v_cvt_pk_bf16_f32 v194, v116, v117
    v_cvt_pk_bf16_f32 v195, v118, v119
    s_waitcnt lgkmcnt(2)
    v_mfma_f32_32x32x16_bf16 v[128:143], v[68:71], v[148:151], v[128:143]
    v_cvt_pk_bf16_f32 v196, v120, v121
    v_cvt_pk_bf16_f32 v197, v122, v123
    v_cvt_pk_bf16_f32 v198, v124, v125
    v_cvt_pk_bf16_f32 v199, v126, v127
    s_waitcnt lgkmcnt(1)
    v_mfma_f32_32x32x16_bf16 v[128:143], v[72:75], v[152:155], v[128:143]
    ds_write_b128 v249, v[192:195] offset:256
    ds_write_b128 v249, v[196:199] offset:272
    s_waitcnt lgkmcnt(2)
    v_mfma_f32_32x32x16_bf16 v[128:143], v[76:79], v[156:159], v[128:143]
    s_nop 7
    s_nop 3
    v_mul_f32 v128, v128, v176
    v_mul_f32 v129, v129, v177
    v_mul_f32 v130, v130, v178
    v_mul_f32 v131, v131, v179
    v_mul_f32 v132, v132, v180
    v_mul_f32 v133, v133, v181
    v_mul_f32 v134, v134, v182
    v_mul_f32 v135, v135, v183
    v_mul_f32 v136, v136, v184
    v_mul_f32 v137, v137, v185
    v_mul_f32 v138, v138, v186
    v_mul_f32 v139, v139, v187
    v_mul_f32 v140, v140, v188
    v_mul_f32 v141, v141, v189
    v_mul_f32 v142, v142, v190
    v_mul_f32 v143, v143, v191
    v_cvt_pk_bf16_f32 v200, v128, v129
    v_cvt_pk_bf16_f32 v201, v130, v131
    v_cvt_pk_bf16_f32 v202, v132, v133
    v_cvt_pk_bf16_f32 v203, v134, v135
    v_cvt_pk_bf16_f32 v204, v136, v137
    v_cvt_pk_bf16_f32 v205, v138, v139
    v_cvt_pk_bf16_f32 v206, v140, v141
    v_cvt_pk_bf16_f32 v207, v142, v143
    ds_write_b128 v249, v[200:203] offset:384
    ds_write_b128 v249, v[204:207] offset:400
K2_COPY:
    v_mbcnt_lo_u32_b32 v228, -1, 0
    v_mbcnt_hi_u32_b32 v228, -1, v228
    s_lshl_b32 s45, s3, 1
    v_lshrrev_b32 v229, 5, v228
    v_and_b32 v228, 31, v228
    v_add_u32 v229, s45, v229
    v_lshlrev_b32 v228, 4, v228
    v_mul_u32_u24 v230, 528, v229
    v_lshl_add_u32 v231, v229, 9, v228
    v_add_u32 v230, v230, v228
    v_add_u32 v230, 91232, v230
    s_mul_i32 s44, s24, 25088
    s_waitcnt lgkmcnt(0)
    s_barrier
    ds_read_b128 v[0:3], v230 offset:0
    ds_read_b128 v[4:7], v230 offset:8448
    ds_read_b128 v[8:11], v230 offset:16896
    ds_read_b128 v[12:15], v230 offset:25344
    v_cmp_gt_u32 vcc, s25, v229
    v_add_u32 v229, 16, v229
    s_waitcnt lgkmcnt(3)
    s_mov_b64 exec, vcc
    buffer_store_dwordx4 v[0:3], v231, s[20:23], s44 offen sc1 nt
    s_mov_b64 exec, -1
    s_add_u32 s44, s44, 8192
    v_cmp_gt_u32 vcc, s25, v229
    v_add_u32 v229, 16, v229
    s_waitcnt lgkmcnt(2)
    s_mov_b64 exec, vcc
    buffer_store_dwordx4 v[4:7], v231, s[20:23], s44 offen sc1 nt
    s_mov_b64 exec, -1
    s_add_u32 s44, s44, 8192
    v_cmp_gt_u32 vcc, s25, v229
    v_add_u32 v229, 16, v229
    s_waitcnt lgkmcnt(1)
    s_mov_b64 exec, vcc
    buffer_store_dwordx4 v[8:11], v231, s[20:23], s44 offen sc1 nt
    s_mov_b64 exec, -1
    s_add_u32 s44, s44, 8192
    v_cmp_gt_u32 vcc, s25, v229
    v_add_u32 v229, 16, v229
    s_waitcnt lgkmcnt(0)
    s_mov_b64 exec, vcc
    buffer_store_dwordx4 v[12:15], v231, s[20:23], s44 offen sc1 nt
    s_mov_b64 exec, -1
    s_add_u32 s44, s44, 8192
    s_branch K2_NEXTWIN
K2_SLOWEP:
    ds_read_b128 v[144:147], v231 offset:16
    ds_read_b128 v[148:151], v231 offset:48
    ds_read_b128 v[152:155], v231 offset:80
    ds_read_b128 v[156:159], v231 offset:112
    ds_read_b128 v[160:163], v231 offset:144
    ds_read_b128 v[164:167], v231 offset:176
    ds_read_b128 v[168:171], v231 offset:208
    s_waitcnt vmcnt(0)
    ds_read_b128 v[172:175], v231 offset:240
    s_waitcnt lgkmcnt(7)
    v_mfma_f32_32x32x16_bf16 v[80:95], v[0:3], v[144:147], 0
    ds_read_b128 v[144:147], v231 offset:272
    s_waitcnt lgkmcnt(7)
    v_mfma_f32_32x32x16_bf16 v[80:95], v[4:7], v[148:151], v[80:95]
    ds_read_b128 v[148:151], v231 offset:304
    s_waitcnt lgkmcnt(7)
    v_mfma_f32_32x32x16_bf16 v[80:95], v[8:11], v[152:155], v[80:95]
    ds_read_b128 v[152:155], v231 offset:336
    s_waitcnt lgkmcnt(7)
    v_mfma_f32_32x32x16_bf16 v[80:95], v[12:15], v[156:159], v[80:95]
    ds_read_b128 v[156:159], v231 offset:368
    s_waitcnt lgkmcnt(7)
    v_mfma_f32_32x32x16_bf16 v[80:95], v[16:19], v[160:163], v[80:95]
    ds_read_b128 v[160:163], v231 offset:400
    s_waitcnt lgkmcnt(7)
    v_mfma_f32_32x32x16_bf16 v[80:95], v[20:23], v[164:167], v[80:95]
    ds_read_b128 v[164:167], v231 offset:432
    s_waitcnt lgkmcnt(7)
    v_mfma_f32_32x32x16_bf16 v[80:95], v[24:27], v[168:171], v[80:95]
    ds_read_b128 v[168:171], v231 offset:464
    s_waitcnt lgkmcnt(7)
    v_mfma_f32_32x32x16_bf16 v[80:95], v[28:31], v[172:175], v[80:95]
    ds_read_b128 v[172:175], v231 offset:496
    s_waitcnt lgkmcnt(7)
    v_mfma_f32_32x32x16_bf16 v[96:111], v[32:35], v[144:147], 0
    ds_read_b128 v[144:147], v231 offset:1040
    s_waitcnt lgkmcnt(7)
    v_mfma_f32_32x32x16_bf16 v[96:111], v[36:39], v[148:151], v[96:111]
    ds_read_b128 v[148:151], v231 offset:1072
    s_waitcnt lgkmcnt(7)
    v_mfma_f32_32x32x16_bf16 v[96:111], v[40:43], v[152:155], v[96:111]
    ds_read_b128 v[152:155], v231 offset:1104
    s_waitcnt lgkmcnt(7)
    v_mfma_f32_32x32x16_bf16 v[96:111], v[44:47], v[156:159], v[96:111]
    ds_read_b128 v[156:159], v231 offset:1136
    s_waitcnt lgkmcnt(7)
    v_mfma_f32_32x32x16_bf16 v[96:111], v[48:51], v[160:163], v[96:111]
    ds_read_b128 v[160:163], v231 offset:528
    s_waitcnt lgkmcnt(7)
    v_mfma_f32_32x32x16_bf16 v[96:111], v[52:55], v[164:167], v[96:111]
    ds_read_b128 v[164:167], v231 offset:560
    s_waitcnt lgkmcnt(7)
    v_mfma_f32_32x32x16_bf16 v[96:111], v[56:59], v[168:171], v[96:111]
    ds_read_b128 v[168:171], v231 offset:592
    s_waitcnt lgkmcnt(7)
    v_mfma_f32_32x32x16_bf16 v[96:111], v[60:63], v[172:175], v[96:111]
    ds_read_b128 v[172:175], v231 offset:624
    s_waitcnt lgkmcnt(7)
    v_mfma_f32_32x32x16_bf16 v[96:111], v[64:67], v[144:147], v[96:111]
    ds_read_b128 v[144:147], v231 offset:656
    s_waitcnt lgkmcnt(7)
    v_mfma_f32_32x32x16_bf16 v[96:111], v[68:71], v[148:151], v[96:111]
    ds_read_b128 v[148:151], v231 offset:688
    s_waitcnt lgkmcnt(7)
    v_mfma_f32_32x32x16_bf16 v[96:111], v[72:75], v[152:155], v[96:111]
    ds_read_b128 v[152:155], v231 offset:720
    s_waitcnt lgkmcnt(7)
    v_mfma_f32_32x32x16_bf16 v[96:111], v[76:79], v[156:159], v[96:111]
    ds_read_b128 v[156:159], v231 offset:752
    s_waitcnt lgkmcnt(7)
    v_mfma_f32_32x32x16_bf16 v[112:127], v[32:35], v[160:163], 0
    ds_read_b128 v[160:163], v231 offset:1168
    s_waitcnt lgkmcnt(7)
    v_mfma_f32_32x32x16_bf16 v[112:127], v[36:39], v[164:167], v[112:127]
    ds_read_b128 v[164:167], v231 offset:1200
    s_waitcnt lgkmcnt(7)
    v_mfma_f32_32x32x16_bf16 v[112:127], v[40:43], v[168:171], v[112:127]
    ds_read_b128 v[168:171], v231 offset:1232
    s_waitcnt lgkmcnt(7)
    v_mfma_f32_32x32x16_bf16 v[112:127], v[44:47], v[172:175], v[112:127]
    ds_read_b128 v[172:175], v231 offset:1264
    s_waitcnt lgkmcnt(7)
    v_mfma_f32_32x32x16_bf16 v[112:127], v[48:51], v[144:147], v[112:127]
    ds_read_b128 v[144:147], v231 offset:784
    s_waitcnt lgkmcnt(7)
    v_mfma_f32_32x32x16_bf16 v[112:127], v[52:55], v[148:151], v[112:127]
    ds_read_b128 v[148:151], v231 offset:816
    s_waitcnt lgkmcnt(7)
    v_mfma_f32_32x32x16_bf16 v[112:127], v[56:59], v[152:155], v[112:127]
    ds_read_b128 v[152:155], v231 offset:848
    s_waitcnt lgkmcnt(7)
    v_mfma_f32_32x32x16_bf16 v[112:127], v[60:63], v[156:159], v[112:127]
    ds_read_b128 v[156:159], v231 offset:880
    s_waitcnt lgkmcnt(7)
    v_mfma_f32_32x32x16_bf16 v[112:127], v[64:67], v[160:163], v[112:127]
    ds_read_b128 v[160:163], v231 offset:912
    s_waitcnt lgkmcnt(7)
    v_mfma_f32_32x32x16_bf16 v[112:127], v[68:71], v[164:167], v[112:127]
    ds_read_b128 v[164:167], v231 offset:944
    s_waitcnt lgkmcnt(7)
    v_mfma_f32_32x32x16_bf16 v[112:127], v[72:75], v[168:171], v[112:127]
    ds_read_b128 v[168:171], v231 offset:976
    s_waitcnt lgkmcnt(7)
    v_mfma_f32_32x32x16_bf16 v[112:127], v[76:79], v[172:175], v[112:127]
    ds_read_b128 v[172:175], v231 offset:1008
    s_waitcnt lgkmcnt(7)
    v_mfma_f32_32x32x16_bf16 v[128:143], v[32:35], v[144:147], 0
    ds_read_b128 v[144:147], v231 offset:1296
    s_waitcnt lgkmcnt(7)
    v_mfma_f32_32x32x16_bf16 v[128:143], v[36:39], v[148:151], v[128:143]
    ds_read_b128 v[148:151], v231 offset:1328
    s_waitcnt lgkmcnt(7)
    v_mfma_f32_32x32x16_bf16 v[128:143], v[40:43], v[152:155], v[128:143]
    ds_read_b128 v[152:155], v231 offset:1360
    s_waitcnt lgkmcnt(7)
    v_mfma_f32_32x32x16_bf16 v[128:143], v[44:47], v[156:159], v[128:143]
    ds_read_b128 v[156:159], v231 offset:1392
    s_waitcnt lgkmcnt(7)
    v_mfma_f32_32x32x16_bf16 v[128:143], v[48:51], v[160:163], v[128:143]
    s_waitcnt lgkmcnt(6)
    v_mfma_f32_32x32x16_bf16 v[128:143], v[52:55], v[164:167], v[128:143]
    s_waitcnt lgkmcnt(5)
    v_mfma_f32_32x32x16_bf16 v[128:143], v[56:59], v[168:171], v[128:143]
    s_waitcnt lgkmcnt(4)
    v_mfma_f32_32x32x16_bf16 v[128:143], v[60:63], v[172:175], v[128:143]
    s_waitcnt lgkmcnt(3)
    v_mfma_f32_32x32x16_bf16 v[128:143], v[64:67], v[144:147], v[128:143]
    s_waitcnt lgkmcnt(2)
    v_mfma_f32_32x32x16_bf16 v[128:143], v[68:71], v[148:151], v[128:143]
    s_waitcnt lgkmcnt(1)
    v_mfma_f32_32x32x16_bf16 v[128:143], v[72:75], v[152:155], v[128:143]
    s_waitcnt lgkmcnt(0)
    v_mfma_f32_32x32x16_bf16 v[128:143], v[76:79], v[156:159], v[128:143]
    s_lshl_b32 s44, s24, 2
    s_add_u32 s44, s44, s88
    s_lshl_b32 s44, s44, 14
    s_nop 7
    s_cmp_lg_u32 s30, 0
    s_cbranch_scc1 K2_NOLOADP
    s_mov_b32 s45, s44
    buffer_load_dwordx4 v[0:3], v228, s[16:19], s45 offen offset:0 sc1
    buffer_load_dwordx4 v[4:7], v228, s[16:19], s45 offen offset:1024 sc1
    buffer_load_dwordx4 v[8:11], v228, s[16:19], s45 offen offset:2048 sc1
    buffer_load_dwordx4 v[12:15], v228, s[16:19], s45 offen offset:3072 sc1
    s_add_u32 s45, s45, 4096
    buffer_load_dwordx4 v[16:19], v228, s[16:19], s45 offen offset:0 sc1
    buffer_load_dwordx4 v[20:23], v228, s[16:19], s45 offen offset:1024 sc1
    buffer_load_dwordx4 v[24:27], v228, s[16:19], s45 offen offset:2048 sc1
    buffer_load_dwordx4 v[28:31], v228, s[16:19], s45 offen offset:3072 sc1
    s_add_u32 s45, s45, 4096
    buffer_load_dwordx4 v[32:35], v228, s[16:19], s45 offen offset:0 sc1
    buffer_load_dwordx4 v[36:39], v228, s[16:19], s45 offen offset:1024 sc1
    buffer_load_dwordx4 v[40:43], v228, s[16:19], s45 offen offset:2048 sc1
    buffer_load_dwordx4 v[44:47], v228, s[16:19], s45 offen offset:3072 sc1
    s_add_u32 s45, s45, 4096
    buffer_load_dwordx4 v[48:51], v228, s[16:19], s45 offen offset:0 sc1
    buffer_load_dwordx4 v[52:55], v228, s[16:19], s45 offen offset:1024 sc1
    buffer_load_dwordx4 v[56:59], v228, s[16:19], s45 offen offset:2048 sc1
    buffer_load_dwordx4 v[60:63], v228, s[16:19], s45 offen offset:3072 sc1
    s_waitcnt vmcnt(0)
    v_add_f32 v80, v80, v0
    v_add_f32 v81, v81, v1
    v_add_f32 v82, v82, v2
    v_add_f32 v83, v83, v3
    v_add_f32 v84, v84, v4
    v_add_f32 v85, v85, v5
    v_add_f32 v86, v86, v6
    v_add_f32 v87, v87, v7
    v_add_f32 v88, v88, v8
    v_add_f32 v89, v89, v9
    v_add_f32 v90, v90, v10
    v_add_f32 v91, v91, v11
    v_add_f32 v92, v92, v12
    v_add_f32 v93, v93, v13
    v_add_f32 v94, v94, v14
    v_add_f32 v95, v95, v15
    v_add_f32 v96, v96, v16
    v_add_f32 v97, v97, v17
    v_add_f32 v98, v98, v18
    v_add_f32 v99, v99, v19
    v_add_f32 v100, v100, v20
    v_add_f32 v101, v101, v21
    v_add_f32 v102, v102, v22
    v_add_f32 v103, v103, v23
    v_add_f32 v104, v104, v24
    v_add_f32 v105, v105, v25
    v_add_f32 v106, v106, v26
    v_add_f32 v107, v107, v27
    v_add_f32 v108, v108, v28
    v_add_f32 v109, v109, v29
    v_add_f32 v110, v110, v30
    v_add_f32 v111, v111, v31
    v_add_f32 v112, v112, v32
    v_add_f32 v113, v113, v33
    v_add_f32 v114, v114, v34
    v_add_f32 v115, v115, v35
    v_add_f32 v116, v116, v36
    v_add_f32 v117, v117, v37
    v_add_f32 v118, v118, v38
    v_add_f32 v119, v119, v39
    v_add_f32 v120, v120, v40
    v_add_f32 v121, v121, v41
    v_add_f32 v122, v122, v42
    v_add_f32 v123, v123, v43
    v_add_f32 v124, v124, v44
    v_add_f32 v125, v125, v45
    v_add_f32 v126, v126, v46
    v_add_f32 v127, v127, v47
    v_add_f32 v128, v128, v48
    v_add_f32 v129, v129, v49
    v_add_f32 v130, v130, v50
    v_add_f32 v131, v131, v51
    v_add_f32 v132, v132, v52
    v_add_f32 v133, v133, v53
    v_add_f32 v134, v134, v54
    v_add_f32 v135, v135, v55
    v_add_f32 v136, v136, v56
    v_add_f32 v137, v137, v57
    v_add_f32 v138, v138, v58
    v_add_f32 v139, v139, v59
    v_add_f32 v140, v140, v60
    v_add_f32 v141, v141, v61
    v_add_f32 v142, v142, v62
    v_add_f32 v143, v143, v63
K2_NOLOADP:
    s_cmp_lg_u32 s31, 0
    s_cbranch_scc1 K2_FINAL
    buffer_store_dwordx4 v[80:83], v228, s[16:19], s44 offen offset:0 sc1
    buffer_store_dwordx4 v[84:87], v228, s[16:19], s44 offen offset:1024 sc1
    buffer_store_dwordx4 v[88:91], v228, s[16:19], s44 offen offset:2048 sc1
    buffer_store_dwordx4 v[92:95], v228, s[16:19], s44 offen offset:3072 sc1
    s_add_u32 s44, s44, 4096
    buffer_store_dwordx4 v[96:99], v228, s[16:19], s44 offen offset:0 sc1
    buffer_store_dwordx4 v[100:103], v228, s[16:19], s44 offen offset:1024 sc1
    buffer_store_dwordx4 v[104:107], v228, s[16:19], s44 offen offset:2048 sc1
    buffer_store_dwordx4 v[108:111], v228, s[16:19], s44 offen offset:3072 sc1
    s_add_u32 s44, s44, 4096
    buffer_store_dwordx4 v[112:115], v228, s[16:19], s44 offen offset:0 sc1
    buffer_store_dwordx4 v[116:119], v228, s[16:19], s44 offen offset:1024 sc1
    buffer_store_dwordx4 v[120:123], v228, s[16:19], s44 offen offset:2048 sc1
    buffer_store_dwordx4 v[124:127], v228, s[16:19], s44 offen offset:3072 sc1
    s_add_u32 s44, s44, 4096
    buffer_store_dwordx4 v[128:131], v228, s[16:19], s44 offen offset:0 sc1
    buffer_store_dwordx4 v[132:135], v228, s[16:19], s44 offen offset:1024 sc1
    buffer_store_dwordx4 v[136:139], v228, s[16:19], s44 offen offset:2048 sc1
    buffer_store_dwordx4 v[140:143], v228, s[16:19], s44 offen offset:3072 sc1
    s_branch K2_NEXTWIN
K2_FINAL:
    v_mul_f32 v176, 0xbfb8aa3b, v80
    v_mul_f32 v177, 0xbfb8aa3b, v81
    v_mul_f32 v178, 0xbfb8aa3b, v82
    v_mul_f32 v179, 0xbfb8aa3b, v83
    v_mul_f32 v180, 0xbfb8aa3b, v84
    v_mul_f32 v181, 0xbfb8aa3b, v85
    v_mul_f32 v182, 0xbfb8aa3b, v86
    v_mul_f32 v183, 0xbfb8aa3b, v87
    v_mul_f32 v184, 0xbfb8aa3b, v88
    v_mul_f32 v185, 0xbfb8aa3b, v89
    v_mul_f32 v186, 0xbfb8aa3b, v90
    v_mul_f32 v187, 0xbfb8aa3b, v91
    v_mul_f32 v188, 0xbfb8aa3b, v92
    v_mul_f32 v189, 0xbfb8aa3b, v93
    v_mul_f32 v190, 0xbfb8aa3b, v94
    v_mul_f32 v191, 0xbfb8aa3b, v95
    v_exp_f32 v176, v176
    v_exp_f32 v177, v177
    v_exp_f32 v178, v178
    v_exp_f32 v179, v179
    v_exp_f32 v180, v180
    v_exp_f32 v181, v181
    v_exp_f32 v182, v182
    v_exp_f32 v183, v183
    v_exp_f32 v184, v184
    v_exp_f32 v185, v185
    v_exp_f32 v186, v186
    v_exp_f32 v187, v187
    v_exp_f32 v188, v188
    v_exp_f32 v189, v189
    v_exp_f32 v190, v190
    v_exp_f32 v191, v191
    v_add_f32 v176, 1.0, v176
    v_add_f32 v177, 1.0, v177
    v_add_f32 v178, 1.0, v178
    v_add_f32 v179, 1.0, v179
    v_add_f32 v180, 1.0, v180
    v_add_f32 v181, 1.0, v181
    v_add_f32 v182, 1.0, v182
    v_add_f32 v183, 1.0, v183
    v_add_f32 v184, 1.0, v184
    v_add_f32 v185, 1.0, v185
    v_add_f32 v186, 1.0, v186
    v_add_f32 v187, 1.0, v187
    v_add_f32 v188, 1.0, v188
    v_add_f32 v189, 1.0, v189
    v_add_f32 v190, 1.0, v190
    v_add_f32 v191, 1.0, v191
    v_rcp_f32 v176, v176
    v_rcp_f32 v177, v177
    v_rcp_f32 v178, v178
    v_rcp_f32 v179, v179
    v_rcp_f32 v180, v180
    v_rcp_f32 v181, v181
    v_rcp_f32 v182, v182
    v_rcp_f32 v183, v183
    v_rcp_f32 v184, v184
    v_rcp_f32 v185, v185
    v_rcp_f32 v186, v186
    v_rcp_f32 v187, v187
    v_rcp_f32 v188, v188
    v_rcp_f32 v189, v189
    v_rcp_f32 v190, v190
    v_rcp_f32 v191, v191
    v_cvt_pk_bf16_f32 v192, v80, v81
    v_cvt_pk_bf16_f32 v193, v82, v83
    v_cvt_pk_bf16_f32 v194, v84, v85
    v_cvt_pk_bf16_f32 v195, v86, v87
    v_cvt_pk_bf16_f32 v196, v88, v89
    v_cvt_pk_bf16_f32 v197, v90, v91
    v_cvt_pk_bf16_f32 v198, v92, v93
    v_cvt_pk_bf16_f32 v199, v94, v95
    s_mov_b64 exec, vcc
    buffer_store_dwordx4 v[192:195], v248, s[20:23], s46 offen offset:0
    buffer_store_dwordx4 v[196:199], v248, s[20:23], s46 offen offset:16
    s_mov_b64 exec, -1
    v_mul_f32 v96, v96, v176
    v_mul_f32 v97, v97, v177
    v_mul_f32 v98, v98, v178
    v_mul_f32 v99, v99, v179
    v_mul_f32 v100, v100, v180
    v_mul_f32 v101, v101, v181
    v_mul_f32 v102, v102, v182
    v_mul_f32 v103, v103, v183
    v_mul_f32 v104, v104, v184
    v_mul_f32 v105, v105, v185
    v_mul_f32 v106, v106, v186
    v_mul_f32 v107, v107, v187
    v_mul_f32 v108, v108, v188
    v_mul_f32 v109, v109, v189
    v_mul_f32 v110, v110, v190
    v_mul_f32 v111, v111, v191
    v_cvt_pk_bf16_f32 v200, v96, v97
    v_cvt_pk_bf16_f32 v201, v98, v99
    v_cvt_pk_bf16_f32 v202, v100, v101
    v_cvt_pk_bf16_f32 v203, v102, v103
    v_cvt_pk_bf16_f32 v204, v104, v105
    v_cvt_pk_bf16_f32 v205, v106, v107
    v_cvt_pk_bf16_f32 v206, v108, v109
    v_cvt_pk_bf16_f32 v207, v110, v111
    s_mov_b64 exec, vcc
    buffer_store_dwordx4 v[200:203], v248, s[20:23], s46 offen offset:128
    buffer_store_dwordx4 v[204:207], v248, s[20:23], s46 offen offset:144
    s_mov_b64 exec, -1
    v_mul_f32 v112, v112, v176
    v_mul_f32 v113, v113, v177
    v_mul_f32 v114, v114, v178
    v_mul_f32 v115, v115, v179
    v_mul_f32 v116, v116, v180
    v_mul_f32 v117, v117, v181
    v_mul_f32 v118, v118, v182
    v_mul_f32 v119, v119, v183
    v_mul_f32 v120, v120, v184
    v_mul_f32 v121, v121, v185
    v_mul_f32 v122, v122, v186
    v_mul_f32 v123, v123, v187
    v_mul_f32 v124, v124, v188
    v_mul_f32 v125, v125, v189
    v_mul_f32 v126, v126, v190
    v_mul_f32 v127, v127, v191
    v_cvt_pk_bf16_f32 v192, v112, v113
    v_cvt_pk_bf16_f32 v193, v114, v115
    v_cvt_pk_bf16_f32 v194, v116, v117
    v_cvt_pk_bf16_f32 v195, v118, v119
    v_cvt_pk_bf16_f32 v196, v120, v121
    v_cvt_pk_bf16_f32 v197, v122, v123
    v_cvt_pk_bf16_f32 v198, v124, v125
    v_cvt_pk_bf16_f32 v199, v126, v127
    s_mov_b64 exec, vcc
    buffer_store_dwordx4 v[192:195], v248, s[20:23], s46 offen offset:256
    buffer_store_dwordx4 v[196:199], v248, s[20:23], s46 offen offset:272
    s_mov_b64 exec, -1
    v_mul_f32 v128, v128, v176
    v_mul_f32 v129, v129, v177
    v_mul_f32 v130, v130, v178
    v_mul_f32 v131, v131, v179
    v_mul_f32 v132, v132, v180
    v_mul_f32 v133, v133, v181
    v_mul_f32 v134, v134, v182
    v_mul_f32 v135, v135, v183
    v_mul_f32 v136, v136, v184
    v_mul_f32 v137, v137, v185
    v_mul_f32 v138, v138, v186
    v_mul_f32 v139, v139, v187
    v_mul_f32 v140, v140, v188
    v_mul_f32 v141, v141, v189
    v_mul_f32 v142, v142, v190
    v_mul_f32 v143, v143, v191
    v_cvt_pk_bf16_f32 v200, v128, v129
    v_cvt_pk_bf16_f32 v201, v130, v131
    v_cvt_pk_bf16_f32 v202, v132, v133
    v_cvt_pk_bf16_f32 v203, v134, v135
    v_cvt_pk_bf16_f32 v204, v136, v137
    v_cvt_pk_bf16_f32 v205, v138, v139
    v_cvt_pk_bf16_f32 v206, v140, v141
    v_cvt_pk_bf16_f32 v207, v142, v143
    s_mov_b64 exec, vcc
    buffer_store_dwordx4 v[200:203], v248, s[20:23], s46 offen offset:384
    buffer_store_dwordx4 v[204:207], v248, s[20:23], s46 offen offset:400
    s_mov_b64 exec, -1
K2_NEXTWIN:
    s_cmp_lg_u32 s31, 0
    s_cbranch_scc1 K2_END
    s_mov_b32 s26, s32
    s_mov_b32 s28, s33
    s_mov_b32 s29, s34
    s_mov_b32 s30, 0
    s_waitcnt vmcnt(0) lgkmcnt(0)
    s_barrier
    s_branch K2_WIN
K2_END:
    s_endpgm
.section .rodata,"a"
.p2align 6
.amdhsa_kernel gather_scatter__tensor_product_equiv_equiformer__graph_kernel
  .amdhsa_next_free_vgpr 256
  .amdhsa_next_free_sgpr 102
  .amdhsa_accum_offset 256
  .amdhsa_group_segment_fixed_size 0
  .amdhsa_kernarg_size 96
  .amdhsa_user_sgpr_count 2
  .amdhsa_user_sgpr_kernarg_segment_ptr 1
  .amdhsa_system_sgpr_workgroup_id_x 1
.end_amdhsa_kernel
```
